```python
import torch

def _softmax(x, axis=-1):
    return torch.softmax(x, dim=axis)
def _gelu(x):
    return torch.nn.functional.gelu(x, approximate="tanh")
def _silu(x):
    return torch.nn.functional.silu(x)
def _sigmoid(x):
    return torch.sigmoid(x)
def _layernorm(x, axis=-1, eps=1e-5):
    m = x.mean(dim=axis, keepdim=True)
    v = x.var(dim=axis, keepdim=True, unbiased=False)
    return (x - m) / torch.sqrt(v + eps)
def _scatter_add(tgt, idx, src, axis=0):
    return tgt.clone().index_add_(axis, idx, src)
def _segment_sum(src, seg, n):
    out = torch.zeros((n,) + src.shape[1:], dtype=src.dtype)
    return out.index_add_(0, seg, src)
def _pad(x, pw):
    flat = tuple(v for pair in reversed(pw) for v in pair)
    return torch.nn.functional.pad(x, flat)

kernel_name = 'gated_mix__mha_block_cached__sliding_block_cached__decode'

def setup_inputs():

    _w = (lambda a: (lambda t: t.to(torch.bfloat16) if t.is_floating_point() else t)(torch.as_tensor(a)))
    def _A_setup():
        B, Sq, D = 4, 1, 512
        H, Sk, Dh = 32, 8192, 128
        return {
            "x": _w((lambda *s: torch.randn(*s, dtype=torch.bfloat16) * 0.05)(B, Sq, D)),
            "k_cache": _w((lambda *s: torch.randn(*s, dtype=torch.bfloat16) * 6.4)(B, H, Sk, Dh)),
            "v_cache": _w((lambda *s: torch.randn(*s, dtype=torch.bfloat16) * 0.05)(B, H, Sk, Dh)),
            "wq": _w((lambda *s: torch.randn(*s, dtype=torch.bfloat16) * 6.4)(D, H * Dh) * (D ** -0.5)),
            "wo": _w((lambda *s: torch.randn(*s, dtype=torch.bfloat16) * 0.05)(H * Dh, D) * ((H * Dh) ** -0.5)),
        }
    _A_in = _A_setup()

    def _B_setup():
        B, Sq, D = 4, 1, 512
        Hq, Hkv, Sk, Dh = 32, 8, 8192, 128
        assert Hq % Hkv == 0, (Hq, Hkv)
        return {
            "x": _w((lambda *s: torch.randn(*s, dtype=torch.bfloat16) * 0.05)(B, Sq, D)),
            "k_cache": _w((lambda *s: torch.randn(*s, dtype=torch.bfloat16) * 6.4)(B, Hkv, Sk, Dh)),
            "v_cache": _w((lambda *s: torch.randn(*s, dtype=torch.bfloat16) * 0.05)(B, Hkv, Sk, Dh)),
            "wq": _w((lambda *s: torch.randn(*s, dtype=torch.bfloat16) * 6.4)(D, Hq * Dh) * (D ** -0.5)),
            "wo": _w((lambda *s: torch.randn(*s, dtype=torch.bfloat16) * 0.05)(Hq * Dh, D) * ((Hq * Dh) ** -0.5)),
        }
    _B_in = _B_setup()

    return {
        "A_x": _A_in["x"],
        "A_k_cache": _A_in["k_cache"],
        "A_v_cache": _A_in["v_cache"],
        "A_wq": _A_in["wq"],
        "A_wo": _A_in["wo"],
        "B_x": _B_in["x"],
        "B_k_cache": _B_in["k_cache"],
        "B_v_cache": _B_in["v_cache"],
        "B_wq": _B_in["wq"],
        "B_wo": _B_in["wo"],
        "gate_w": _w((lambda *s: torch.randn(*s, dtype=torch.bfloat16) * 0.05)(512) * 16.0),
    }

def reference(A_x, A_k_cache, A_v_cache, A_wq, A_wo, B_x, B_k_cache, B_v_cache, B_wq, B_wo, gate_w):
    def _A_ref(x, k_cache, v_cache, wq, wo):
        B, Sq, D = x.shape
        H, Dh = 32, 128
        q = (lambda x, *d: x.permute(*d))((x @ wq).reshape(B, Sq, H, Dh), 0, 2, 1, 3)
        scores = torch.einsum("bhqd,bhkd->bhqk", q, k_cache) * (Dh ** -0.5)
        p = _softmax(scores, axis=-1)
        o = torch.einsum("bhqk,bhkd->bhqd", p, v_cache)
        return (lambda x, *d: x.permute(*d))(o, 0, 2, 1, 3).reshape(B, Sq, H * Dh) @ wo

    def _B_ref(x, k_cache, v_cache, wq, wo):
        B, Sq, D = x.shape
        Hq, Dh = 32, 128
        Hkv, Sk = k_cache.shape[1], k_cache.shape[2]
        W = min(4096, max(256, Sk // 4))
        rep = Hq // Hkv
        q = (lambda x, *d: x.permute(*d))((x @ wq).reshape(B, Sq, Hq, Dh), 0, 2, 1, 3)
        k = (lambda x, n, axis: torch.repeat_interleave(x, n, dim=axis))(k_cache[:, :, Sk - W:, :], rep, axis=1)
        v = (lambda x, n, axis: torch.repeat_interleave(x, n, dim=axis))(v_cache[:, :, Sk - W:, :], rep, axis=1)
        scores = torch.einsum("bhqd,bhkd->bhqk", q, k) * (Dh ** -0.5)
        p = _softmax(scores, axis=-1)
        o = torch.einsum("bhqk,bhkd->bhqd", p, v)
        return (lambda x, *d: x.permute(*d))(o, 0, 2, 1, 3).reshape(B, Sq, Hq * Dh) @ wo

    x = A_x
    g = _sigmoid((x * gate_w).sum(-1, keepdims=True))
    a = _A_ref(x, A_k_cache, A_v_cache, A_wq, A_wo)
    b = _B_ref(x, B_k_cache, B_v_cache, B_wq, B_wo)
    return g * a + (1 - g) * b
```

```asm
; @launch grid=(256,1,1) block=(512,1,1) lds=90112
.amdgcn_target "amdgcn-amd-amdhsa--gfx950"
.text
.globl gated_mix__mha_block_cached__sliding_block_cached__decode_kernel
.p2align 8
.type gated_mix__mha_block_cached__sliding_block_cached__decode_kernel,@function
gated_mix__mha_block_cached__sliding_block_cached__decode_kernel:
    s_cmp_ge_u32 s2, 256
    s_cbranch_scc1 L_END
    v_lshrrev_b32 v1, 6, v0
    v_and_b32 v0, 63, v0
    s_and_b32 s4, s2, 7
    v_readfirstlane_b32 s3, v1
    s_lshr_b32 s5, s2, 3
    s_lshl_b32 s20, s5, 16
    s_and_b32 s8, s2, 0xc0
    s_lshl_b32 s8, s8, 18
    s_xor_b32 s20, s20, s8
    s_lshl_b32 s8, s4, 21
    s_xor_b32 s20, s20, s8
    s_mul_i32 s100, s4, 5
    s_add_u32 s100, s100, s5
    s_and_b32 s100, s100, 31
    s_cmp_ge_u32 s3, 4
    s_cbranch_scc1 L_AUX
    s_load_dwordx4 s[28:31], s[0:1], 8
    s_load_dwordx4 s[32:35], s[0:1], 48
    v_and_b32 v34, 15, v0
    v_lshrrev_b32 v35, 4, v0
    s_lshl_b32 s21, s3, 12
    s_add_u32 s20, s20, s21
    v_lshrrev_b32 v36, 2, v34
    v_and_b32 v37, 3, v34
    v_lshlrev_b32 v227, 4, v35
    v_lshl_add_u32 v227, v37, 6, v227
    v_lshl_add_u32 v1, v36, 8, v227
    v_lshlrev_b32 v2, 4, v0
    s_mov_b32 s36, 0x10000000
    s_mov_b32 s37, 0x4000000
    s_mov_b32 s14, s36
    s_mov_b32 s18, s36
    s_mov_b32 s15, 0x20000
    s_mov_b32 s19, 0x20000
    v_mov_b32 v44, 0
    v_mov_b32 v45, 0
    v_mov_b32 v46, 0
    v_mov_b32 v47, 0
    s_lshl_b32 s22, s3, 10
    v_add_u32 v49, s22, v2
    ds_write_b128 v49, v[44:47] offset:0
    ds_write_b128 v2, v[44:47] offset:4096
    s_waitcnt lgkmcnt(0)
    s_barrier
    s_mov_b64 s[12:13], s[28:29]
    s_mov_b64 s[16:17], s[28:29]
    s_xor_b32 s21, s20, 0x0
    buffer_load_dwordx4 v[64:67], v1, s[12:15], s21 offen offset:0 nt
    buffer_load_dwordx4 v[68:71], v1, s[12:15], s21 offen offset:1024 nt
    buffer_load_dwordx4 v[72:75], v1, s[12:15], s21 offen offset:2048 nt
    buffer_load_dwordx4 v[76:79], v1, s[12:15], s21 offen offset:3072 nt
    s_xor_b32 s21, s20, 0x4000
    buffer_load_dwordx4 v[80:83], v1, s[12:15], s21 offen offset:0 nt
    s_load_dwordx2 s[24:25], s[0:1], 104
    s_mov_b32 s26, 0x40000000
    s_mov_b32 s27, 0x20000
    s_mov_b32 s75, 0x3fb8aa3b
    s_mov_b32 s74, 0xbfb8aa3b
    s_mov_b32 s80, 0x11111111
    s_mov_b32 s81, 0x11111111
    s_mov_b32 s70, 1600000
    s_mov_b32 s45, 4
    s_mov_b32 s47, 4
    s_mov_b32 s49, 0
    v_and_b32 v28, 1, v0
    v_cmp_eq_u32 vcc, 1, v28
    v_mov_b32 v29, 0x0c0c0100
    v_mov_b32 v30, 0x01000c0c
    v_cndmask_b32 v29, v29, v30, vcc
    v_mov_b32 v30, 0x0c0c0302
    v_mov_b32 v31, 0x03020c0c
    v_cndmask_b32 v30, v30, v31, vcc
    v_bfe_u32 v28, v0, 1, 2
    v_mov_b32 v31, 0x0c0c0c0c
    v_cmp_eq_u32 vcc, 0, v28
    s_nop 1
    v_cndmask_b32 v4, v31, v29, vcc
    v_cndmask_b32 v8, v31, v30, vcc
    v_cmp_eq_u32 vcc, 1, v28
    s_nop 1
    v_cndmask_b32 v5, v31, v29, vcc
    v_cndmask_b32 v9, v31, v30, vcc
    v_cmp_eq_u32 vcc, 2, v28
    s_nop 1
    v_cndmask_b32 v6, v31, v29, vcc
    v_cndmask_b32 v10, v31, v30, vcc
    v_cmp_eq_u32 vcc, 3, v28
    s_nop 1
    v_cndmask_b32 v7, v31, v29, vcc
    v_cndmask_b32 v11, v31, v30, vcc
    v_mov_b32 v244, 0xff61b1e6
    v_lshlrev_b32 v242, 2, v36
    v_lshlrev_b32 v240, 4, v35
    v_lshl_add_u32 v240, v36, 6, v240
    v_add_u32 v238, 40960, v240
    v_lshl_add_u32 v228, v36, 8, v227
    v_and_b32 v36, 1, v35
    v_lshrrev_b32 v37, 5, v0
    v_lshlrev_b32 v38, 5, v34
    v_lshl_add_u32 v38, v36, 4, v38
    s_lshl_b32 s23, s3, 9
    s_add_u32 s23, s23, 15360
    v_add_u32 v224, s23, v38
    v_mul_u32_u24 v231, 2176, v37
    v_add_u32 v231, v231, v224
    s_lshl_b32 s23, s3, 2
    s_add_u32 s22, s23, 17408
    v_mov_b32 v225, s22
    v_lshrrev_b32 v34, 3, v34
    v_lshlrev_b32 v243, 2, v34
    v_lshlrev_b32 v241, 4, v35
    v_lshl_add_u32 v241, v34, 6, v241
    v_add_u32 v241, 73728, v241
    v_mul_u32_u24 v34, 2176, v34
    v_add_u32 v232, v34, v225
    s_lshl_b32 s23, s3, 4
    s_add_u32 s23, s23, 17424
    v_lshlrev_b32 v226, 2, v35
    v_add_u32 v226, s23, v226
    v_add_u32 v233, v34, v226
    v_mov_b32 v234, 4
    v_mov_b32 v235, 0
    s_lshl_b32 s22, s3, 12
    v_add_u32 v239, s22, v238
    v_mov_b32 v236, v1
    v_mov_b32 v237, v1
    s_waitcnt vmcnt(4)
    buffer_load_dwordx4 v[84:87], v1, s[12:15], s21 offen offset:1024 nt
    s_waitcnt vmcnt(4)
    buffer_load_dwordx4 v[88:91], v1, s[12:15], s21 offen offset:2048 nt
    s_waitcnt vmcnt(4)
    buffer_load_dwordx4 v[92:95], v1, s[12:15], s21 offen offset:3072 nt
    s_waitcnt vmcnt(4)
    s_xor_b32 s21, s20, 0x8000
    buffer_load_dwordx4 v[96:99], v1, s[12:15], s21 offen offset:0 nt
    s_waitcnt vmcnt(4)
    buffer_load_dwordx4 v[100:103], v1, s[12:15], s21 offen offset:1024 nt
    s_waitcnt vmcnt(4)
    buffer_load_dwordx4 v[104:107], v1, s[12:15], s21 offen offset:2048 nt
    s_waitcnt vmcnt(4)
    buffer_load_dwordx4 v[108:111], v1, s[12:15], s21 offen offset:3072 nt
    s_waitcnt vmcnt(4)
    s_xor_b32 s21, s20, 0xc000
    buffer_load_dwordx4 v[112:115], v1, s[12:15], s21 offen offset:0 nt
    s_waitcnt vmcnt(4)
    buffer_load_dwordx4 v[116:119], v1, s[12:15], s21 offen offset:1024 nt
    s_waitcnt vmcnt(4)
    buffer_load_dwordx4 v[120:123], v1, s[12:15], s21 offen offset:2048 nt
    s_waitcnt vmcnt(4)
    buffer_load_dwordx4 v[124:127], v1, s[12:15], s21 offen offset:3072 nt
    s_waitcnt vmcnt(4)
    s_xor_b32 s21, s20, 0x80000
    buffer_load_dwordx4 v[128:131], v1, s[12:15], s21 offen offset:0 nt
    s_waitcnt vmcnt(4)
    buffer_load_dwordx4 v[132:135], v1, s[12:15], s21 offen offset:1024 nt
    s_waitcnt vmcnt(4)
    buffer_load_dwordx4 v[136:139], v1, s[12:15], s21 offen offset:2048 nt
    s_waitcnt vmcnt(4)
    buffer_load_dwordx4 v[140:143], v1, s[12:15], s21 offen offset:3072 nt
    s_waitcnt vmcnt(4)
    s_xor_b32 s21, s20, 0x84000
    buffer_load_dwordx4 v[144:147], v1, s[12:15], s21 offen offset:0 nt
    ds_add_u32 v235, v234 offset:4172
    s_waitcnt vmcnt(4)
    buffer_load_dwordx4 v[148:151], v1, s[12:15], s21 offen offset:1024 nt
    s_waitcnt vmcnt(4)
    buffer_load_dwordx4 v[152:155], v1, s[12:15], s21 offen offset:2048 nt
    s_waitcnt vmcnt(4)
    buffer_load_dwordx4 v[156:159], v1, s[12:15], s21 offen offset:3072 nt
    s_waitcnt vmcnt(4)
    s_xor_b32 s21, s20, 0x88000
    buffer_load_dwordx4 v[160:163], v1, s[12:15], s21 offen offset:0 nt
    s_waitcnt vmcnt(4)
    buffer_load_dwordx4 v[164:167], v1, s[12:15], s21 offen offset:1024 nt
    s_waitcnt vmcnt(4)
    buffer_load_dwordx4 v[168:171], v1, s[12:15], s21 offen offset:2048 nt
    s_waitcnt vmcnt(4)
    buffer_load_dwordx4 v[172:175], v1, s[12:15], s21 offen offset:3072 nt
    s_waitcnt vmcnt(4)
    s_xor_b32 s21, s20, 0x8c000
    buffer_load_dwordx4 v[176:179], v1, s[12:15], s21 offen offset:0 nt
    s_waitcnt vmcnt(4)
    buffer_load_dwordx4 v[180:183], v1, s[12:15], s21 offen offset:1024 nt
    s_waitcnt vmcnt(4)
    buffer_load_dwordx4 v[184:187], v1, s[12:15], s21 offen offset:2048 nt
    s_waitcnt vmcnt(4)
    buffer_load_dwordx4 v[188:191], v1, s[12:15], s21 offen offset:3072 nt
    s_xor_b32 s20, s20, 0x100000
    s_xor_b32 s21, s20, 0x4000
    s_or_b32 s40, s20, 3077
L_QW:
    ds_read_b32 v44, v235 offset:4168
    s_waitcnt lgkmcnt(0)
    v_readfirstlane_b32 s71, v44
    s_cmp_ge_u32 s71, 192
    s_cbranch_scc1 L_QWD
    s_sleep 1
    s_sub_u32 s70, s70, 1
    s_cbranch_scc0 L_QW
    s_mov_b32 s70, 0
L_QWD:
    ds_read_b128 v[12:15], v227 offset:13312
    s_waitcnt lgkmcnt(0)
    s_mov_b32 s22, 3932160
    s_load_dword s95, s[24:25], s22
    v_mfma_f32_16x16x32_bf16 v[16:19], v[64:67], v[12:15], 0
    v_mfma_f32_16x16x32_bf16 v[20:23], v[68:71], v[12:15], 0
    v_mfma_f32_16x16x32_bf16 v[24:27], v[72:75], v[12:15], 0
    v_mfma_f32_16x16x32_bf16 v[28:31], v[76:79], v[12:15], 0
    v_mfma_f32_16x16x32_bf16 v[32:35], v[80:83], v[12:15], 0
    v_mfma_f32_16x16x32_bf16 v[36:39], v[84:87], v[12:15], 0
    v_mfma_f32_16x16x32_bf16 v[40:43], v[88:91], v[12:15], 0
    v_mfma_f32_16x16x32_bf16 v[44:47], v[92:95], v[12:15], 0
    s_waitcnt vmcnt(5)
    buffer_load_dwordx4 v[64:67], v236, s[12:15], s20 offen offset:0 nt
    v_mov_b32_dpp v48, v16 quad_perm:[0,0,0,0] row_mask:0xf bank_mask:0xf
    v_mov_b32_dpp v49, v20 quad_perm:[0,0,0,0] row_mask:0xf bank_mask:0xf
    v_mov_b32_dpp v50, v24 quad_perm:[0,0,0,0] row_mask:0xf bank_mask:0xf
    v_mov_b32_dpp v51, v28 quad_perm:[0,0,0,0] row_mask:0xf bank_mask:0xf
    v_add_f32_dpp v48, v17, v48 quad_perm:[1,1,1,1] row_mask:0xf bank_mask:0xf
    v_add_f32_dpp v49, v21, v49 quad_perm:[1,1,1,1] row_mask:0xf bank_mask:0xf
    v_add_f32_dpp v50, v25, v50 quad_perm:[1,1,1,1] row_mask:0xf bank_mask:0xf
    v_add_f32_dpp v51, v29, v51 quad_perm:[1,1,1,1] row_mask:0xf bank_mask:0xf
    v_add_f32_dpp v48, v18, v48 quad_perm:[2,2,2,2] row_mask:0xf bank_mask:0xf
    v_add_f32_dpp v49, v22, v49 quad_perm:[2,2,2,2] row_mask:0xf bank_mask:0xf
    v_add_f32_dpp v50, v26, v50 quad_perm:[2,2,2,2] row_mask:0xf bank_mask:0xf
    v_add_f32_dpp v51, v30, v51 quad_perm:[2,2,2,2] row_mask:0xf bank_mask:0xf
    v_add_f32_dpp v48, v19, v48 quad_perm:[3,3,3,3] row_mask:0xf bank_mask:0xf
    v_add_f32_dpp v49, v23, v49 quad_perm:[3,3,3,3] row_mask:0xf bank_mask:0xf
    v_add_f32_dpp v50, v27, v50 quad_perm:[3,3,3,3] row_mask:0xf bank_mask:0xf
    v_add_f32_dpp v51, v31, v51 quad_perm:[3,3,3,3] row_mask:0xf bank_mask:0xf
    v_cvt_pk_bf16_f32 v56, v48, v49
    v_cvt_pk_bf16_f32 v57, v50, v51
    v_lshlrev_b32 v48, 16, v56
    v_and_b32 v49, 0xffff0000, v56
    v_lshlrev_b32 v50, 16, v57
    v_and_b32 v51, 0xffff0000, v57
    v_mul_f32 v48, 0x3db504f3, v48
    v_mul_f32 v49, 0x3db504f3, v49
    v_mul_f32 v50, 0x3db504f3, v50
    v_mul_f32 v51, 0x3db504f3, v51
    v_cvt_pk_bf16_f32 v56, v48, v49
    v_cvt_pk_bf16_f32 v57, v50, v51
    v_lshlrev_b32 v48, 16, v56
    v_and_b32 v49, 0xffff0000, v56
    v_lshlrev_b32 v50, 16, v57
    v_and_b32 v51, 0xffff0000, v57
    v_max3_f32 v244, v244, v48, v49
    v_max3_f32 v244, v244, v50, v51
    s_waitcnt vmcnt(5)
    buffer_load_dwordx4 v[68:71], v236, s[12:15], s20 offen offset:1024 nt
    v_mov_b32_dpp v52, v32 quad_perm:[0,0,0,0] row_mask:0xf bank_mask:0xf
    v_mov_b32_dpp v53, v36 quad_perm:[0,0,0,0] row_mask:0xf bank_mask:0xf
    v_mov_b32_dpp v54, v40 quad_perm:[0,0,0,0] row_mask:0xf bank_mask:0xf
    v_mov_b32_dpp v55, v44 quad_perm:[0,0,0,0] row_mask:0xf bank_mask:0xf
    v_add_f32_dpp v52, v33, v52 quad_perm:[1,1,1,1] row_mask:0xf bank_mask:0xf
    v_add_f32_dpp v53, v37, v53 quad_perm:[1,1,1,1] row_mask:0xf bank_mask:0xf
    v_add_f32_dpp v54, v41, v54 quad_perm:[1,1,1,1] row_mask:0xf bank_mask:0xf
    v_add_f32_dpp v55, v45, v55 quad_perm:[1,1,1,1] row_mask:0xf bank_mask:0xf
    v_add_f32_dpp v52, v34, v52 quad_perm:[2,2,2,2] row_mask:0xf bank_mask:0xf
    v_add_f32_dpp v53, v38, v53 quad_perm:[2,2,2,2] row_mask:0xf bank_mask:0xf
    v_add_f32_dpp v54, v42, v54 quad_perm:[2,2,2,2] row_mask:0xf bank_mask:0xf
    v_add_f32_dpp v55, v46, v55 quad_perm:[2,2,2,2] row_mask:0xf bank_mask:0xf
    v_add_f32_dpp v52, v35, v52 quad_perm:[3,3,3,3] row_mask:0xf bank_mask:0xf
    v_add_f32_dpp v53, v39, v53 quad_perm:[3,3,3,3] row_mask:0xf bank_mask:0xf
    v_add_f32_dpp v54, v43, v54 quad_perm:[3,3,3,3] row_mask:0xf bank_mask:0xf
    v_add_f32_dpp v55, v47, v55 quad_perm:[3,3,3,3] row_mask:0xf bank_mask:0xf
    v_cvt_pk_bf16_f32 v58, v52, v53
    v_cvt_pk_bf16_f32 v59, v54, v55
    v_lshlrev_b32 v52, 16, v58
    v_and_b32 v53, 0xffff0000, v58
    v_lshlrev_b32 v54, 16, v59
    v_and_b32 v55, 0xffff0000, v59
    v_mul_f32 v52, 0x3db504f3, v52
    v_mul_f32 v53, 0x3db504f3, v53
    v_mul_f32 v54, 0x3db504f3, v54
    v_mul_f32 v55, 0x3db504f3, v55
    v_cvt_pk_bf16_f32 v58, v52, v53
    v_cvt_pk_bf16_f32 v59, v54, v55
    v_lshlrev_b32 v52, 16, v58
    v_and_b32 v53, 0xffff0000, v58
    v_lshlrev_b32 v54, 16, v59
    v_and_b32 v55, 0xffff0000, v59
    v_max3_f32 v244, v244, v52, v53
    v_max3_f32 v244, v244, v54, v55
    s_mov_b64 exec, s[80:81]
    ds_write_b128 v239, v[56:59] offset:0
    s_mov_b64 exec, -1
    s_waitcnt vmcnt(5)
    buffer_load_dwordx4 v[72:75], v236, s[12:15], s20 offen offset:2048 nt
    v_mfma_f32_16x16x32_bf16 v[16:19], v[96:99], v[12:15], 0
    v_mfma_f32_16x16x32_bf16 v[20:23], v[100:103], v[12:15], 0
    v_mfma_f32_16x16x32_bf16 v[24:27], v[104:107], v[12:15], 0
    v_mfma_f32_16x16x32_bf16 v[28:31], v[108:111], v[12:15], 0
    s_nop 4
    v_mov_b32_dpp v48, v16 quad_perm:[0,0,0,0] row_mask:0xf bank_mask:0xf
    v_mov_b32_dpp v49, v20 quad_perm:[0,0,0,0] row_mask:0xf bank_mask:0xf
    v_mov_b32_dpp v50, v24 quad_perm:[0,0,0,0] row_mask:0xf bank_mask:0xf
    v_mov_b32_dpp v51, v28 quad_perm:[0,0,0,0] row_mask:0xf bank_mask:0xf
    v_add_f32_dpp v48, v17, v48 quad_perm:[1,1,1,1] row_mask:0xf bank_mask:0xf
    v_add_f32_dpp v49, v21, v49 quad_perm:[1,1,1,1] row_mask:0xf bank_mask:0xf
    v_add_f32_dpp v50, v25, v50 quad_perm:[1,1,1,1] row_mask:0xf bank_mask:0xf
    v_add_f32_dpp v51, v29, v51 quad_perm:[1,1,1,1] row_mask:0xf bank_mask:0xf
    v_add_f32_dpp v48, v18, v48 quad_perm:[2,2,2,2] row_mask:0xf bank_mask:0xf
    v_add_f32_dpp v49, v22, v49 quad_perm:[2,2,2,2] row_mask:0xf bank_mask:0xf
    v_add_f32_dpp v50, v26, v50 quad_perm:[2,2,2,2] row_mask:0xf bank_mask:0xf
    v_add_f32_dpp v51, v30, v51 quad_perm:[2,2,2,2] row_mask:0xf bank_mask:0xf
    v_add_f32_dpp v48, v19, v48 quad_perm:[3,3,3,3] row_mask:0xf bank_mask:0xf
    v_add_f32_dpp v49, v23, v49 quad_perm:[3,3,3,3] row_mask:0xf bank_mask:0xf
    v_add_f32_dpp v50, v27, v50 quad_perm:[3,3,3,3] row_mask:0xf bank_mask:0xf
    v_add_f32_dpp v51, v31, v51 quad_perm:[3,3,3,3] row_mask:0xf bank_mask:0xf
    v_cvt_pk_bf16_f32 v56, v48, v49
    v_cvt_pk_bf16_f32 v57, v50, v51
    v_lshlrev_b32 v48, 16, v56
    v_and_b32 v49, 0xffff0000, v56
    v_lshlrev_b32 v50, 16, v57
    v_and_b32 v51, 0xffff0000, v57
    v_mul_f32 v48, 0x3db504f3, v48
    v_mul_f32 v49, 0x3db504f3, v49
    v_mul_f32 v50, 0x3db504f3, v50
    v_mul_f32 v51, 0x3db504f3, v51
    v_cvt_pk_bf16_f32 v56, v48, v49
    v_cvt_pk_bf16_f32 v57, v50, v51
    v_lshlrev_b32 v48, 16, v56
    v_and_b32 v49, 0xffff0000, v56
    v_lshlrev_b32 v50, 16, v57
    v_and_b32 v51, 0xffff0000, v57
    v_max3_f32 v244, v244, v48, v49
    v_max3_f32 v244, v244, v50, v51
    v_mfma_f32_16x16x32_bf16 v[32:35], v[112:115], v[12:15], 0
    v_mfma_f32_16x16x32_bf16 v[36:39], v[116:119], v[12:15], 0
    v_mfma_f32_16x16x32_bf16 v[40:43], v[120:123], v[12:15], 0
    v_mfma_f32_16x16x32_bf16 v[44:47], v[124:127], v[12:15], 0
    s_nop 4
    v_mov_b32_dpp v52, v32 quad_perm:[0,0,0,0] row_mask:0xf bank_mask:0xf
    v_mov_b32_dpp v53, v36 quad_perm:[0,0,0,0] row_mask:0xf bank_mask:0xf
    v_mov_b32_dpp v54, v40 quad_perm:[0,0,0,0] row_mask:0xf bank_mask:0xf
    v_mov_b32_dpp v55, v44 quad_perm:[0,0,0,0] row_mask:0xf bank_mask:0xf
    v_add_f32_dpp v52, v33, v52 quad_perm:[1,1,1,1] row_mask:0xf bank_mask:0xf
    v_add_f32_dpp v53, v37, v53 quad_perm:[1,1,1,1] row_mask:0xf bank_mask:0xf
    v_add_f32_dpp v54, v41, v54 quad_perm:[1,1,1,1] row_mask:0xf bank_mask:0xf
    v_add_f32_dpp v55, v45, v55 quad_perm:[1,1,1,1] row_mask:0xf bank_mask:0xf
    v_add_f32_dpp v52, v34, v52 quad_perm:[2,2,2,2] row_mask:0xf bank_mask:0xf
    v_add_f32_dpp v53, v38, v53 quad_perm:[2,2,2,2] row_mask:0xf bank_mask:0xf
    v_add_f32_dpp v54, v42, v54 quad_perm:[2,2,2,2] row_mask:0xf bank_mask:0xf
    v_add_f32_dpp v55, v46, v55 quad_perm:[2,2,2,2] row_mask:0xf bank_mask:0xf
    v_add_f32_dpp v52, v35, v52 quad_perm:[3,3,3,3] row_mask:0xf bank_mask:0xf
    v_add_f32_dpp v53, v39, v53 quad_perm:[3,3,3,3] row_mask:0xf bank_mask:0xf
    v_add_f32_dpp v54, v43, v54 quad_perm:[3,3,3,3] row_mask:0xf bank_mask:0xf
    v_add_f32_dpp v55, v47, v55 quad_perm:[3,3,3,3] row_mask:0xf bank_mask:0xf
    v_cvt_pk_bf16_f32 v58, v52, v53
    v_cvt_pk_bf16_f32 v59, v54, v55
    v_lshlrev_b32 v52, 16, v58
    v_and_b32 v53, 0xffff0000, v58
    v_lshlrev_b32 v54, 16, v59
    v_and_b32 v55, 0xffff0000, v59
    v_mul_f32 v52, 0x3db504f3, v52
    v_mul_f32 v53, 0x3db504f3, v53
    v_mul_f32 v54, 0x3db504f3, v54
    v_mul_f32 v55, 0x3db504f3, v55
    v_cvt_pk_bf16_f32 v58, v52, v53
    v_cvt_pk_bf16_f32 v59, v54, v55
    v_lshlrev_b32 v52, 16, v58
    v_and_b32 v53, 0xffff0000, v58
    v_lshlrev_b32 v54, 16, v59
    v_and_b32 v55, 0xffff0000, v59
    v_max3_f32 v244, v244, v52, v53
    v_max3_f32 v244, v244, v54, v55
    s_mov_b64 exec, s[80:81]
    ds_write_b128 v239, v[56:59] offset:256
    s_mov_b64 exec, -1
    s_waitcnt vmcnt(5)
    buffer_load_dwordx4 v[76:79], v236, s[12:15], s20 offen offset:3072 nt
    v_mfma_f32_16x16x32_bf16 v[16:19], v[128:131], v[12:15], 0
    v_mfma_f32_16x16x32_bf16 v[20:23], v[132:135], v[12:15], 0
    v_mfma_f32_16x16x32_bf16 v[24:27], v[136:139], v[12:15], 0
    v_mfma_f32_16x16x32_bf16 v[28:31], v[140:143], v[12:15], 0
    s_nop 4
    v_mov_b32_dpp v48, v16 quad_perm:[0,0,0,0] row_mask:0xf bank_mask:0xf
    v_mov_b32_dpp v49, v20 quad_perm:[0,0,0,0] row_mask:0xf bank_mask:0xf
    v_mov_b32_dpp v50, v24 quad_perm:[0,0,0,0] row_mask:0xf bank_mask:0xf
    v_mov_b32_dpp v51, v28 quad_perm:[0,0,0,0] row_mask:0xf bank_mask:0xf
    v_add_f32_dpp v48, v17, v48 quad_perm:[1,1,1,1] row_mask:0xf bank_mask:0xf
    v_add_f32_dpp v49, v21, v49 quad_perm:[1,1,1,1] row_mask:0xf bank_mask:0xf
    v_add_f32_dpp v50, v25, v50 quad_perm:[1,1,1,1] row_mask:0xf bank_mask:0xf
    v_add_f32_dpp v51, v29, v51 quad_perm:[1,1,1,1] row_mask:0xf bank_mask:0xf
    v_add_f32_dpp v48, v18, v48 quad_perm:[2,2,2,2] row_mask:0xf bank_mask:0xf
    v_add_f32_dpp v49, v22, v49 quad_perm:[2,2,2,2] row_mask:0xf bank_mask:0xf
    v_add_f32_dpp v50, v26, v50 quad_perm:[2,2,2,2] row_mask:0xf bank_mask:0xf
    v_add_f32_dpp v51, v30, v51 quad_perm:[2,2,2,2] row_mask:0xf bank_mask:0xf
    v_add_f32_dpp v48, v19, v48 quad_perm:[3,3,3,3] row_mask:0xf bank_mask:0xf
    v_add_f32_dpp v49, v23, v49 quad_perm:[3,3,3,3] row_mask:0xf bank_mask:0xf
    v_add_f32_dpp v50, v27, v50 quad_perm:[3,3,3,3] row_mask:0xf bank_mask:0xf
    v_add_f32_dpp v51, v31, v51 quad_perm:[3,3,3,3] row_mask:0xf bank_mask:0xf
    v_cvt_pk_bf16_f32 v56, v48, v49
    v_cvt_pk_bf16_f32 v57, v50, v51
    v_lshlrev_b32 v48, 16, v56
    v_and_b32 v49, 0xffff0000, v56
    v_lshlrev_b32 v50, 16, v57
    v_and_b32 v51, 0xffff0000, v57
    v_mul_f32 v48, 0x3db504f3, v48
    v_mul_f32 v49, 0x3db504f3, v49
    v_mul_f32 v50, 0x3db504f3, v50
    v_mul_f32 v51, 0x3db504f3, v51
    v_cvt_pk_bf16_f32 v56, v48, v49
    v_cvt_pk_bf16_f32 v57, v50, v51
    v_lshlrev_b32 v48, 16, v56
    v_and_b32 v49, 0xffff0000, v56
    v_lshlrev_b32 v50, 16, v57
    v_and_b32 v51, 0xffff0000, v57
    v_max3_f32 v244, v244, v48, v49
    v_max3_f32 v244, v244, v50, v51
    s_waitcnt vmcnt(5)
    buffer_load_dwordx4 v[80:83], v237, s[16:19], s21 offen offset:0 nt
    v_mfma_f32_16x16x32_bf16 v[32:35], v[144:147], v[12:15], 0
    v_mfma_f32_16x16x32_bf16 v[36:39], v[148:151], v[12:15], 0
    v_mfma_f32_16x16x32_bf16 v[40:43], v[152:155], v[12:15], 0
    v_mfma_f32_16x16x32_bf16 v[44:47], v[156:159], v[12:15], 0
    s_nop 4
    v_mov_b32_dpp v52, v32 quad_perm:[0,0,0,0] row_mask:0xf bank_mask:0xf
    v_mov_b32_dpp v53, v36 quad_perm:[0,0,0,0] row_mask:0xf bank_mask:0xf
    v_mov_b32_dpp v54, v40 quad_perm:[0,0,0,0] row_mask:0xf bank_mask:0xf
    v_mov_b32_dpp v55, v44 quad_perm:[0,0,0,0] row_mask:0xf bank_mask:0xf
    v_add_f32_dpp v52, v33, v52 quad_perm:[1,1,1,1] row_mask:0xf bank_mask:0xf
    v_add_f32_dpp v53, v37, v53 quad_perm:[1,1,1,1] row_mask:0xf bank_mask:0xf
    v_add_f32_dpp v54, v41, v54 quad_perm:[1,1,1,1] row_mask:0xf bank_mask:0xf
    v_add_f32_dpp v55, v45, v55 quad_perm:[1,1,1,1] row_mask:0xf bank_mask:0xf
    v_add_f32_dpp v52, v34, v52 quad_perm:[2,2,2,2] row_mask:0xf bank_mask:0xf
    v_add_f32_dpp v53, v38, v53 quad_perm:[2,2,2,2] row_mask:0xf bank_mask:0xf
    v_add_f32_dpp v54, v42, v54 quad_perm:[2,2,2,2] row_mask:0xf bank_mask:0xf
    v_add_f32_dpp v55, v46, v55 quad_perm:[2,2,2,2] row_mask:0xf bank_mask:0xf
    v_add_f32_dpp v52, v35, v52 quad_perm:[3,3,3,3] row_mask:0xf bank_mask:0xf
    v_add_f32_dpp v53, v39, v53 quad_perm:[3,3,3,3] row_mask:0xf bank_mask:0xf
    v_add_f32_dpp v54, v43, v54 quad_perm:[3,3,3,3] row_mask:0xf bank_mask:0xf
    v_add_f32_dpp v55, v47, v55 quad_perm:[3,3,3,3] row_mask:0xf bank_mask:0xf
    v_cvt_pk_bf16_f32 v58, v52, v53
    v_cvt_pk_bf16_f32 v59, v54, v55
    v_lshlrev_b32 v52, 16, v58
    v_and_b32 v53, 0xffff0000, v58
    v_lshlrev_b32 v54, 16, v59
    v_and_b32 v55, 0xffff0000, v59
    v_mul_f32 v52, 0x3db504f3, v52
    v_mul_f32 v53, 0x3db504f3, v53
    v_mul_f32 v54, 0x3db504f3, v54
    v_mul_f32 v55, 0x3db504f3, v55
    v_cvt_pk_bf16_f32 v58, v52, v53
    v_cvt_pk_bf16_f32 v59, v54, v55
    v_lshlrev_b32 v52, 16, v58
    v_and_b32 v53, 0xffff0000, v58
    v_lshlrev_b32 v54, 16, v59
    v_and_b32 v55, 0xffff0000, v59
    v_max3_f32 v244, v244, v52, v53
    v_max3_f32 v244, v244, v54, v55
    s_mov_b64 exec, s[80:81]
    ds_write_b128 v239, v[56:59] offset:512
    s_mov_b64 exec, -1
    v_mfma_f32_16x16x32_bf16 v[16:19], v[160:163], v[12:15], 0
    v_mfma_f32_16x16x32_bf16 v[20:23], v[164:167], v[12:15], 0
    v_mfma_f32_16x16x32_bf16 v[24:27], v[168:171], v[12:15], 0
    v_mfma_f32_16x16x32_bf16 v[28:31], v[172:175], v[12:15], 0
    s_nop 4
    v_mov_b32_dpp v48, v16 quad_perm:[0,0,0,0] row_mask:0xf bank_mask:0xf
    v_mov_b32_dpp v49, v20 quad_perm:[0,0,0,0] row_mask:0xf bank_mask:0xf
    v_mov_b32_dpp v50, v24 quad_perm:[0,0,0,0] row_mask:0xf bank_mask:0xf
    v_mov_b32_dpp v51, v28 quad_perm:[0,0,0,0] row_mask:0xf bank_mask:0xf
    v_add_f32_dpp v48, v17, v48 quad_perm:[1,1,1,1] row_mask:0xf bank_mask:0xf
    v_add_f32_dpp v49, v21, v49 quad_perm:[1,1,1,1] row_mask:0xf bank_mask:0xf
    v_add_f32_dpp v50, v25, v50 quad_perm:[1,1,1,1] row_mask:0xf bank_mask:0xf
    v_add_f32_dpp v51, v29, v51 quad_perm:[1,1,1,1] row_mask:0xf bank_mask:0xf
    v_add_f32_dpp v48, v18, v48 quad_perm:[2,2,2,2] row_mask:0xf bank_mask:0xf
    v_add_f32_dpp v49, v22, v49 quad_perm:[2,2,2,2] row_mask:0xf bank_mask:0xf
    v_add_f32_dpp v50, v26, v50 quad_perm:[2,2,2,2] row_mask:0xf bank_mask:0xf
    v_add_f32_dpp v51, v30, v51 quad_perm:[2,2,2,2] row_mask:0xf bank_mask:0xf
    v_add_f32_dpp v48, v19, v48 quad_perm:[3,3,3,3] row_mask:0xf bank_mask:0xf
    v_add_f32_dpp v49, v23, v49 quad_perm:[3,3,3,3] row_mask:0xf bank_mask:0xf
    v_add_f32_dpp v50, v27, v50 quad_perm:[3,3,3,3] row_mask:0xf bank_mask:0xf
    v_add_f32_dpp v51, v31, v51 quad_perm:[3,3,3,3] row_mask:0xf bank_mask:0xf
    v_cvt_pk_bf16_f32 v56, v48, v49
    v_cvt_pk_bf16_f32 v57, v50, v51
    v_lshlrev_b32 v48, 16, v56
    v_and_b32 v49, 0xffff0000, v56
    v_lshlrev_b32 v50, 16, v57
    v_and_b32 v51, 0xffff0000, v57
    v_mul_f32 v48, 0x3db504f3, v48
    v_mul_f32 v49, 0x3db504f3, v49
    v_mul_f32 v50, 0x3db504f3, v50
    v_mul_f32 v51, 0x3db504f3, v51
    v_cvt_pk_bf16_f32 v56, v48, v49
    v_cvt_pk_bf16_f32 v57, v50, v51
    v_lshlrev_b32 v48, 16, v56
    v_and_b32 v49, 0xffff0000, v56
    v_lshlrev_b32 v50, 16, v57
    v_and_b32 v51, 0xffff0000, v57
    v_max3_f32 v244, v244, v48, v49
    v_max3_f32 v244, v244, v50, v51
    s_waitcnt vmcnt(5)
    buffer_load_dwordx4 v[84:87], v237, s[16:19], s21 offen offset:1024 nt
    v_mfma_f32_16x16x32_bf16 v[32:35], v[176:179], v[12:15], 0
    v_mfma_f32_16x16x32_bf16 v[36:39], v[180:183], v[12:15], 0
    v_mfma_f32_16x16x32_bf16 v[40:43], v[184:187], v[12:15], 0
    v_mfma_f32_16x16x32_bf16 v[44:47], v[188:191], v[12:15], 0
    s_nop 4
    v_mov_b32_dpp v52, v32 quad_perm:[0,0,0,0] row_mask:0xf bank_mask:0xf
    v_mov_b32_dpp v53, v36 quad_perm:[0,0,0,0] row_mask:0xf bank_mask:0xf
    v_mov_b32_dpp v54, v40 quad_perm:[0,0,0,0] row_mask:0xf bank_mask:0xf
    v_mov_b32_dpp v55, v44 quad_perm:[0,0,0,0] row_mask:0xf bank_mask:0xf
    v_add_f32_dpp v52, v33, v52 quad_perm:[1,1,1,1] row_mask:0xf bank_mask:0xf
    v_add_f32_dpp v53, v37, v53 quad_perm:[1,1,1,1] row_mask:0xf bank_mask:0xf
    v_add_f32_dpp v54, v41, v54 quad_perm:[1,1,1,1] row_mask:0xf bank_mask:0xf
    v_add_f32_dpp v55, v45, v55 quad_perm:[1,1,1,1] row_mask:0xf bank_mask:0xf
    v_add_f32_dpp v52, v34, v52 quad_perm:[2,2,2,2] row_mask:0xf bank_mask:0xf
    v_add_f32_dpp v53, v38, v53 quad_perm:[2,2,2,2] row_mask:0xf bank_mask:0xf
    v_add_f32_dpp v54, v42, v54 quad_perm:[2,2,2,2] row_mask:0xf bank_mask:0xf
    v_add_f32_dpp v55, v46, v55 quad_perm:[2,2,2,2] row_mask:0xf bank_mask:0xf
    v_add_f32_dpp v52, v35, v52 quad_perm:[3,3,3,3] row_mask:0xf bank_mask:0xf
    v_add_f32_dpp v53, v39, v53 quad_perm:[3,3,3,3] row_mask:0xf bank_mask:0xf
    v_add_f32_dpp v54, v43, v54 quad_perm:[3,3,3,3] row_mask:0xf bank_mask:0xf
    v_add_f32_dpp v55, v47, v55 quad_perm:[3,3,3,3] row_mask:0xf bank_mask:0xf
    v_cvt_pk_bf16_f32 v58, v52, v53
    v_cvt_pk_bf16_f32 v59, v54, v55
    v_lshlrev_b32 v52, 16, v58
    v_and_b32 v53, 0xffff0000, v58
    v_lshlrev_b32 v54, 16, v59
    v_and_b32 v55, 0xffff0000, v59
    v_mul_f32 v52, 0x3db504f3, v52
    v_mul_f32 v53, 0x3db504f3, v53
    v_mul_f32 v54, 0x3db504f3, v54
    v_mul_f32 v55, 0x3db504f3, v55
    v_cvt_pk_bf16_f32 v58, v52, v53
    v_cvt_pk_bf16_f32 v59, v54, v55
    v_lshlrev_b32 v52, 16, v58
    v_and_b32 v53, 0xffff0000, v58
    v_lshlrev_b32 v54, 16, v59
    v_and_b32 v55, 0xffff0000, v59
    v_max3_f32 v244, v244, v52, v53
    v_max3_f32 v244, v244, v54, v55
    s_mov_b64 exec, s[80:81]
    ds_write_b128 v239, v[56:59] offset:768
    s_mov_b64 exec, -1
L_K:
    s_xor_b32 s22, s40, s45
    s_and_b32 s22, s22, 0xfc
    s_cbranch_scc1 L_PH
L_KG:
    s_mov_b64 exec, 1
    ds_add_rtn_u32 v229, v235, v234 offset:4128
    s_mov_b64 exec, -1
    s_and_b32 s22, s40, 0x3b00
    v_add_u32 v239, s22, v238
    s_add_u32 s47, s47, 1
    s_waitcnt vmcnt(5)
    buffer_load_dwordx4 v[88:91], v237, s[16:19], s21 offen offset:2048 nt
    s_waitcnt lgkmcnt(0)
    s_mov_b64 exec, 1
    ds_read_b32 v230, v229
    s_mov_b64 exec, -1
    v_mfma_f32_16x16x32_bf16 v[16:19], v[64:67], v[12:15], 0
    s_waitcnt vmcnt(5)
    buffer_load_dwordx4 v[92:95], v237, s[16:19], s21 offen offset:3072 nt
    s_waitcnt lgkmcnt(0)
L_KC:
    v_readfirstlane_b32 s41, v230
    s_bitcmp1_b32 s41, 0
    s_cbranch_scc0 L_SPK
    s_and_b32 s20, s41, 0xfffff000
    s_bitcmp1_b32 s41, 6
    s_cselect_b64 s[50:51], s[32:33], s[28:29]
    s_cselect_b64 s[52:53], s[34:35], s[30:31]
    s_cselect_b32 s14, s37, s36
    s_bitcmp1_b32 s41, 3
    s_cselect_b64 s[12:13], s[52:53], s[50:51]
    s_cselect_b64 s[54:55], -1, 0
    v_cndmask_b32 v236, v1, v2, s[54:55]
    s_and_b32 s22, s41, 1024
    s_lshl_b32 s22, s22, 4
    s_xor_b32 s21, s22, s20
    s_mov_b32 s18, s14
    s_bitcmp1_b32 s41, 2
    s_cselect_b64 s[16:17], s[50:51], s[52:53]
    s_cselect_b64 s[56:57], -1, 0
    v_cndmask_b32 v237, v2, v1, s[56:57]
    v_mfma_f32_16x16x32_bf16 v[20:23], v[68:71], v[12:15], 0
    s_waitcnt vmcnt(5)
    buffer_load_dwordx4 v[64:67], v236, s[12:15], s20 offen offset:0 nt
    v_mfma_f32_16x16x32_bf16 v[24:27], v[72:75], v[12:15], 0
    v_mov_b32_dpp v48, v16 quad_perm:[0,0,0,0] row_mask:0xf bank_mask:0xf
    s_nop 3
    v_mov_b32_dpp v49, v20 quad_perm:[0,0,0,0] row_mask:0xf bank_mask:0xf
    v_add_f32_dpp v48, v17, v48 quad_perm:[1,1,1,1] row_mask:0xf bank_mask:0xf
    s_nop 0
    v_add_f32_dpp v49, v21, v49 quad_perm:[1,1,1,1] row_mask:0xf bank_mask:0xf
    v_add_f32_dpp v48, v18, v48 quad_perm:[2,2,2,2] row_mask:0xf bank_mask:0xf
    s_nop 0
    v_add_f32_dpp v49, v22, v49 quad_perm:[2,2,2,2] row_mask:0xf bank_mask:0xf
    v_add_f32_dpp v48, v19, v48 quad_perm:[3,3,3,3] row_mask:0xf bank_mask:0xf
    s_nop 0
    v_add_f32_dpp v49, v23, v49 quad_perm:[3,3,3,3] row_mask:0xf bank_mask:0xf
    s_waitcnt vmcnt(5)
    buffer_load_dwordx4 v[68:71], v236, s[12:15], s20 offen offset:1024 nt
    v_mfma_f32_16x16x32_bf16 v[28:31], v[76:79], v[12:15], 0
    v_cvt_pk_bf16_f32 v56, v48, v49
    v_lshlrev_b32 v48, 16, v56
    v_and_b32 v49, 0xffff0000, v56
    v_mul_f32 v48, 0x3db504f3, v48
    v_mul_f32 v49, 0x3db504f3, v49
    v_cvt_pk_bf16_f32 v56, v48, v49
    v_lshlrev_b32 v48, 16, v56
    v_and_b32 v49, 0xffff0000, v56
    v_max3_f32 v244, v244, v48, v49
    s_waitcnt vmcnt(5)
    buffer_load_dwordx4 v[72:75], v236, s[12:15], s20 offen offset:2048 nt
    v_mfma_f32_16x16x32_bf16 v[32:35], v[80:83], v[12:15], 0
    v_mov_b32_dpp v50, v24 quad_perm:[0,0,0,0] row_mask:0xf bank_mask:0xf
    v_mov_b32_dpp v51, v28 quad_perm:[0,0,0,0] row_mask:0xf bank_mask:0xf
    s_nop 0
    v_add_f32_dpp v50, v25, v50 quad_perm:[1,1,1,1] row_mask:0xf bank_mask:0xf
    v_add_f32_dpp v51, v29, v51 quad_perm:[1,1,1,1] row_mask:0xf bank_mask:0xf
    s_nop 0
    v_add_f32_dpp v50, v26, v50 quad_perm:[2,2,2,2] row_mask:0xf bank_mask:0xf
    v_add_f32_dpp v51, v30, v51 quad_perm:[2,2,2,2] row_mask:0xf bank_mask:0xf
    s_nop 0
    v_add_f32_dpp v50, v27, v50 quad_perm:[3,3,3,3] row_mask:0xf bank_mask:0xf
    v_add_f32_dpp v51, v31, v51 quad_perm:[3,3,3,3] row_mask:0xf bank_mask:0xf
    s_waitcnt vmcnt(5)
    buffer_load_dwordx4 v[76:79], v236, s[12:15], s20 offen offset:3072 nt
    v_mfma_f32_16x16x32_bf16 v[36:39], v[84:87], v[12:15], 0
    v_cvt_pk_bf16_f32 v57, v50, v51
    v_lshlrev_b32 v50, 16, v57
    v_and_b32 v51, 0xffff0000, v57
    v_mul_f32 v50, 0x3db504f3, v50
    v_mul_f32 v51, 0x3db504f3, v51
    v_cvt_pk_bf16_f32 v57, v50, v51
    v_lshlrev_b32 v50, 16, v57
    v_and_b32 v51, 0xffff0000, v57
    v_max3_f32 v244, v244, v50, v51
    s_waitcnt vmcnt(5)
    buffer_load_dwordx4 v[80:83], v237, s[16:19], s21 offen offset:0 nt
    v_mfma_f32_16x16x32_bf16 v[40:43], v[88:91], v[12:15], 0
    v_mov_b32_dpp v52, v32 quad_perm:[0,0,0,0] row_mask:0xf bank_mask:0xf
    v_mov_b32_dpp v53, v36 quad_perm:[0,0,0,0] row_mask:0xf bank_mask:0xf
    s_nop 0
    v_add_f32_dpp v52, v33, v52 quad_perm:[1,1,1,1] row_mask:0xf bank_mask:0xf
    v_add_f32_dpp v53, v37, v53 quad_perm:[1,1,1,1] row_mask:0xf bank_mask:0xf
    s_nop 0
    v_add_f32_dpp v52, v34, v52 quad_perm:[2,2,2,2] row_mask:0xf bank_mask:0xf
    v_add_f32_dpp v53, v38, v53 quad_perm:[2,2,2,2] row_mask:0xf bank_mask:0xf
    s_nop 0
    v_add_f32_dpp v52, v35, v52 quad_perm:[3,3,3,3] row_mask:0xf bank_mask:0xf
    v_add_f32_dpp v53, v39, v53 quad_perm:[3,3,3,3] row_mask:0xf bank_mask:0xf
    s_waitcnt vmcnt(5)
    buffer_load_dwordx4 v[84:87], v237, s[16:19], s21 offen offset:1024 nt
    v_mfma_f32_16x16x32_bf16 v[44:47], v[92:95], v[12:15], 0
    v_cvt_pk_bf16_f32 v58, v52, v53
    v_lshlrev_b32 v52, 16, v58
    v_and_b32 v53, 0xffff0000, v58
    v_mul_f32 v52, 0x3db504f3, v52
    v_mul_f32 v53, 0x3db504f3, v53
    v_cvt_pk_bf16_f32 v58, v52, v53
    v_lshlrev_b32 v52, 16, v58
    v_and_b32 v53, 0xffff0000, v58
    v_max3_f32 v244, v244, v52, v53
    v_mov_b32_dpp v54, v40 quad_perm:[0,0,0,0] row_mask:0xf bank_mask:0xf
    v_mov_b32_dpp v55, v44 quad_perm:[0,0,0,0] row_mask:0xf bank_mask:0xf
    s_nop 0
    v_add_f32_dpp v54, v41, v54 quad_perm:[1,1,1,1] row_mask:0xf bank_mask:0xf
    v_add_f32_dpp v55, v45, v55 quad_perm:[1,1,1,1] row_mask:0xf bank_mask:0xf
    s_nop 0
    v_add_f32_dpp v54, v42, v54 quad_perm:[2,2,2,2] row_mask:0xf bank_mask:0xf
    v_add_f32_dpp v55, v46, v55 quad_perm:[2,2,2,2] row_mask:0xf bank_mask:0xf
    s_nop 0
    v_add_f32_dpp v54, v43, v54 quad_perm:[3,3,3,3] row_mask:0xf bank_mask:0xf
    v_add_f32_dpp v55, v47, v55 quad_perm:[3,3,3,3] row_mask:0xf bank_mask:0xf
    v_cvt_pk_bf16_f32 v59, v54, v55
    v_lshlrev_b32 v54, 16, v59
    v_and_b32 v55, 0xffff0000, v59
    v_mul_f32 v54, 0x3db504f3, v54
    v_mul_f32 v55, 0x3db504f3, v55
    v_cvt_pk_bf16_f32 v59, v54, v55
    v_lshlrev_b32 v54, 16, v59
    v_and_b32 v55, 0xffff0000, v59
    v_max3_f32 v244, v244, v54, v55
    s_mov_b64 exec, s[80:81]
    ds_write_b128 v239, v[56:59] offset:0
    s_mov_b64 exec, -1
    s_mov_b32 s40, s41
    s_branch L_K
L_A:
    s_xor_b32 s22, s40, s45
    s_and_b32 s22, s22, 0xfc
    s_cbranch_scc1 L_PH
L_AG:
    s_mov_b64 exec, 1
    ds_add_rtn_u32 v229, v235, v234 offset:4128
    s_mov_b64 exec, -1
    s_and_b32 s22, s40, 0x3b00
    v_add_u32 v239, s22, v238
    ds_read_b128 v[56:59], v239
    s_add_u32 s47, s47, 1
    s_waitcnt vmcnt(5)
    buffer_load_dwordx4 v[88:91], v237, s[16:19], s21 offen offset:2048 nt
    s_waitcnt lgkmcnt(0)
    s_mov_b64 exec, 1
    ds_read_b32 v230, v229
    s_mov_b64 exec, -1
    v_lshlrev_b32 v48, 16, v56
    v_and_b32 v49, 0xffff0000, v56
    v_lshlrev_b32 v50, 16, v57
    v_and_b32 v51, 0xffff0000, v57
    v_lshlrev_b32 v52, 16, v58
    v_and_b32 v53, 0xffff0000, v58
    v_lshlrev_b32 v54, 16, v59
    v_and_b32 v55, 0xffff0000, v59
    v_fma_f32 v48, v48, s75, v245
    v_fma_f32 v49, v49, s75, v245
    v_fma_f32 v50, v50, s75, v245
    v_fma_f32 v51, v51, s75, v245
    v_fma_f32 v52, v52, s75, v245
    v_fma_f32 v53, v53, s75, v245
    v_fma_f32 v54, v54, s75, v245
    v_fma_f32 v55, v55, s75, v245
    v_exp_f32 v48, v48
    v_exp_f32 v49, v49
    v_exp_f32 v50, v50
    v_exp_f32 v51, v51
    v_exp_f32 v52, v52
    v_exp_f32 v53, v53
    v_exp_f32 v54, v54
    v_exp_f32 v55, v55
    s_waitcnt vmcnt(5)
    buffer_load_dwordx4 v[92:95], v237, s[16:19], s21 offen offset:3072 nt
    s_waitcnt lgkmcnt(0)
L_AC:
    v_readfirstlane_b32 s41, v230
    s_bitcmp1_b32 s41, 0
    s_cbranch_scc0 L_SPA
    s_and_b32 s20, s41, 0xfffff000
    s_bitcmp1_b32 s41, 6
    s_cselect_b64 s[50:51], s[32:33], s[28:29]
    s_cselect_b64 s[52:53], s[34:35], s[30:31]
    s_cselect_b32 s14, s37, s36
    s_bitcmp1_b32 s41, 3
    s_cselect_b64 s[12:13], s[52:53], s[50:51]
    s_cselect_b64 s[54:55], -1, 0
    v_cndmask_b32 v236, v1, v2, s[54:55]
    s_and_b32 s22, s41, 1024
    s_lshl_b32 s22, s22, 4
    s_xor_b32 s21, s22, s20
    s_mov_b32 s18, s14
    s_bitcmp1_b32 s41, 2
    s_cselect_b64 s[16:17], s[50:51], s[52:53]
    s_cselect_b64 s[56:57], -1, 0
    v_cndmask_b32 v237, v2, v1, s[56:57]
    v_cvt_pk_bf16_f32 v56, v48, v49
    v_cvt_pk_bf16_f32 v57, v50, v51
    v_cvt_pk_bf16_f32 v58, v52, v53
    v_cvt_pk_bf16_f32 v59, v54, v55
    v_perm_b32 v16, v56, v56, v4
    v_perm_b32 v17, v56, v56, v5
    v_perm_b32 v18, v56, v56, v6
    v_perm_b32 v19, v56, v56, v7
    v_perm_b32 v20, v56, v56, v8
    v_perm_b32 v21, v56, v56, v9
    v_perm_b32 v22, v56, v56, v10
    v_perm_b32 v23, v56, v56, v11
    v_mfma_f32_16x16x32_bf16 v[60:63], v[16:19], v[64:67], v[60:63]
    s_nop 0
    v_mfma_f32_16x16x32_bf16 v[60:63], v[20:23], v[68:71], v[60:63]
    v_perm_b32 v24, v57, v57, v4
    v_perm_b32 v25, v57, v57, v5
    v_perm_b32 v26, v57, v57, v6
    v_perm_b32 v27, v57, v57, v7
    s_waitcnt vmcnt(5)
    buffer_load_dwordx4 v[64:67], v236, s[12:15], s20 offen offset:0 nt
    v_mfma_f32_16x16x32_bf16 v[60:63], v[24:27], v[72:75], v[60:63]
    v_perm_b32 v28, v57, v57, v8
    v_perm_b32 v29, v57, v57, v9
    v_perm_b32 v30, v57, v57, v10
    v_perm_b32 v31, v57, v57, v11
    v_add_f32 v48, v48, v52
    v_add_f32 v49, v49, v53
    v_add_f32 v50, v50, v54
    v_add_f32 v51, v51, v55
    v_add_f32 v48, v48, v50
    v_add_f32 v49, v49, v51
    v_add_f32 v48, v48, v49
    v_add_f32 v246, v246, v48
    s_waitcnt vmcnt(5)
    buffer_load_dwordx4 v[68:71], v236, s[12:15], s20 offen offset:1024 nt
    v_mfma_f32_16x16x32_bf16 v[60:63], v[28:31], v[76:79], v[60:63]
    v_perm_b32 v32, v58, v58, v4
    v_perm_b32 v33, v58, v58, v5
    v_perm_b32 v34, v58, v58, v6
    v_perm_b32 v35, v58, v58, v7
    s_waitcnt vmcnt(5)
    buffer_load_dwordx4 v[72:75], v236, s[12:15], s20 offen offset:2048 nt
    v_mfma_f32_16x16x32_bf16 v[60:63], v[32:35], v[80:83], v[60:63]
    v_perm_b32 v36, v58, v58, v8
    v_perm_b32 v37, v58, v58, v9
    v_perm_b32 v38, v58, v58, v10
    v_perm_b32 v39, v58, v58, v11
    s_waitcnt vmcnt(5)
    buffer_load_dwordx4 v[76:79], v236, s[12:15], s20 offen offset:3072 nt
    v_mfma_f32_16x16x32_bf16 v[60:63], v[36:39], v[84:87], v[60:63]
    v_perm_b32 v40, v59, v59, v4
    v_perm_b32 v41, v59, v59, v5
    v_perm_b32 v42, v59, v59, v6
    v_perm_b32 v43, v59, v59, v7
    s_waitcnt vmcnt(5)
    buffer_load_dwordx4 v[80:83], v237, s[16:19], s21 offen offset:0 nt
    v_mfma_f32_16x16x32_bf16 v[60:63], v[40:43], v[88:91], v[60:63]
    v_perm_b32 v44, v59, v59, v8
    v_perm_b32 v45, v59, v59, v9
    v_perm_b32 v46, v59, v59, v10
    v_perm_b32 v47, v59, v59, v11
    s_waitcnt vmcnt(5)
    buffer_load_dwordx4 v[84:87], v237, s[16:19], s21 offen offset:1024 nt
    v_mfma_f32_16x16x32_bf16 v[60:63], v[44:47], v[92:95], v[60:63]
    s_mov_b32 s40, s41
    s_nop 6
    s_branch L_A
L_B:
    s_xor_b32 s22, s40, s45
    s_and_b32 s22, s22, 0xfc
    s_cbranch_scc1 L_PH
L_BG:
    s_mov_b64 exec, 1
    ds_add_rtn_u32 v229, v235, v234 offset:4128
    s_mov_b64 exec, -1
    s_and_b32 s22, s40, 0x3b00
    v_add_u32 v239, s22, v238
    ds_read_b128 v[56:59], v239
    ds_read_b128 v[200:203], v239 offset:128
    s_add_u32 s47, s47, 1
    s_waitcnt vmcnt(5)
    buffer_load_dwordx4 v[88:91], v237, s[16:19], s21 offen offset:2048 nt
    s_waitcnt lgkmcnt(0)
    s_mov_b64 exec, 1
    ds_read_b32 v230, v229
    s_mov_b64 exec, -1
    v_lshlrev_b32 v48, 16, v56
    v_and_b32 v49, 0xffff0000, v56
    v_lshlrev_b32 v50, 16, v57
    v_and_b32 v51, 0xffff0000, v57
    v_lshlrev_b32 v52, 16, v58
    v_and_b32 v53, 0xffff0000, v58
    v_lshlrev_b32 v54, 16, v59
    v_and_b32 v55, 0xffff0000, v59
    v_fma_f32 v48, v48, s75, v245
    v_fma_f32 v49, v49, s75, v245
    v_fma_f32 v50, v50, s75, v245
    v_fma_f32 v51, v51, s75, v245
    v_fma_f32 v52, v52, s75, v245
    v_fma_f32 v53, v53, s75, v245
    v_fma_f32 v54, v54, s75, v245
    v_fma_f32 v55, v55, s75, v245
    v_exp_f32 v48, v48
    v_exp_f32 v49, v49
    v_exp_f32 v50, v50
    v_exp_f32 v51, v51
    v_exp_f32 v52, v52
    v_exp_f32 v53, v53
    v_exp_f32 v54, v54
    v_exp_f32 v55, v55
    s_waitcnt vmcnt(5)
    buffer_load_dwordx4 v[92:95], v237, s[16:19], s21 offen offset:3072 nt
    s_waitcnt lgkmcnt(0)
L_BC:
    v_readfirstlane_b32 s41, v230
    s_bitcmp1_b32 s41, 0
    s_cbranch_scc0 L_SPB
    s_and_b32 s20, s41, 0xfffff000
    s_bitcmp1_b32 s41, 6
    s_cselect_b64 s[50:51], s[32:33], s[28:29]
    s_cselect_b64 s[52:53], s[34:35], s[30:31]
    s_cselect_b32 s14, s37, s36
    s_bitcmp1_b32 s41, 3
    s_cselect_b64 s[12:13], s[52:53], s[50:51]
    s_cselect_b64 s[54:55], -1, 0
    v_cndmask_b32 v236, v1, v2, s[54:55]
    s_and_b32 s22, s41, 1024
    s_lshl_b32 s22, s22, 4
    s_xor_b32 s21, s22, s20
    s_mov_b32 s18, s14
    s_bitcmp1_b32 s41, 2
    s_cselect_b64 s[16:17], s[50:51], s[52:53]
    s_cselect_b64 s[56:57], -1, 0
    v_cndmask_b32 v237, v2, v1, s[56:57]
    v_lshlrev_b32 v192, 16, v200
    v_and_b32 v193, 0xffff0000, v200
    v_lshlrev_b32 v194, 16, v201
    v_and_b32 v195, 0xffff0000, v201
    v_lshlrev_b32 v196, 16, v202
    v_and_b32 v197, 0xffff0000, v202
    v_lshlrev_b32 v198, 16, v203
    v_and_b32 v199, 0xffff0000, v203
    v_fma_f32 v192, v192, s75, v212
    v_fma_f32 v193, v193, s75, v212
    v_fma_f32 v194, v194, s75, v212
    v_fma_f32 v195, v195, s75, v212
    v_fma_f32 v196, v196, s75, v212
    v_fma_f32 v197, v197, s75, v212
    v_fma_f32 v198, v198, s75, v212
    v_fma_f32 v199, v199, s75, v212
    v_exp_f32 v192, v192
    v_exp_f32 v193, v193
    v_exp_f32 v194, v194
    v_exp_f32 v195, v195
    v_exp_f32 v196, v196
    v_exp_f32 v197, v197
    v_exp_f32 v198, v198
    v_exp_f32 v199, v199
    v_cvt_pk_bf16_f32 v56, v48, v49
    v_cvt_pk_bf16_f32 v57, v50, v51
    v_cvt_pk_bf16_f32 v58, v52, v53
    v_cvt_pk_bf16_f32 v59, v54, v55
    v_perm_b32 v16, v56, v56, v4
    v_perm_b32 v17, v56, v56, v5
    v_perm_b32 v18, v56, v56, v6
    v_perm_b32 v19, v56, v56, v7
    v_perm_b32 v20, v56, v56, v8
    v_perm_b32 v21, v56, v56, v9
    v_perm_b32 v22, v56, v56, v10
    v_perm_b32 v23, v56, v56, v11
    v_cvt_pk_bf16_f32 v200, v192, v193
    v_cvt_pk_bf16_f32 v201, v194, v195
    v_cvt_pk_bf16_f32 v202, v196, v197
    v_cvt_pk_bf16_f32 v203, v198, v199
    v_perm_b32 v160, v200, v200, v4
    v_perm_b32 v161, v200, v200, v5
    v_perm_b32 v162, v200, v200, v6
    v_perm_b32 v163, v200, v200, v7
    v_perm_b32 v164, v200, v200, v8
    v_perm_b32 v165, v200, v200, v9
    v_perm_b32 v166, v200, v200, v10
    v_perm_b32 v167, v200, v200, v11
    v_mfma_f32_16x16x32_bf16 v[60:63], v[16:19], v[64:67], v[60:63]
    v_mfma_f32_16x16x32_bf16 v[216:219], v[160:163], v[64:67], v[216:219]
    v_mfma_f32_16x16x32_bf16 v[60:63], v[20:23], v[68:71], v[60:63]
    v_mfma_f32_16x16x32_bf16 v[216:219], v[164:167], v[68:71], v[216:219]
    v_perm_b32 v24, v57, v57, v4
    v_perm_b32 v25, v57, v57, v5
    v_perm_b32 v26, v57, v57, v6
    v_perm_b32 v27, v57, v57, v7
    v_perm_b32 v168, v201, v201, v4
    v_perm_b32 v169, v201, v201, v5
    v_perm_b32 v170, v201, v201, v6
    v_perm_b32 v171, v201, v201, v7
    s_waitcnt vmcnt(5)
    buffer_load_dwordx4 v[64:67], v236, s[12:15], s20 offen offset:0 nt
    v_mfma_f32_16x16x32_bf16 v[60:63], v[24:27], v[72:75], v[60:63]
    v_mfma_f32_16x16x32_bf16 v[216:219], v[168:171], v[72:75], v[216:219]
    v_perm_b32 v28, v57, v57, v8
    v_perm_b32 v29, v57, v57, v9
    v_perm_b32 v30, v57, v57, v10
    v_perm_b32 v31, v57, v57, v11
    v_perm_b32 v172, v201, v201, v8
    v_perm_b32 v173, v201, v201, v9
    v_perm_b32 v174, v201, v201, v10
    v_perm_b32 v175, v201, v201, v11
    v_add_f32 v48, v48, v52
    v_add_f32 v49, v49, v53
    v_add_f32 v50, v50, v54
    v_add_f32 v51, v51, v55
    v_add_f32 v48, v48, v50
    v_add_f32 v49, v49, v51
    v_add_f32 v48, v48, v49
    v_add_f32 v246, v246, v48
    s_waitcnt vmcnt(5)
    buffer_load_dwordx4 v[68:71], v236, s[12:15], s20 offen offset:1024 nt
    v_mfma_f32_16x16x32_bf16 v[60:63], v[28:31], v[76:79], v[60:63]
    v_mfma_f32_16x16x32_bf16 v[216:219], v[172:175], v[76:79], v[216:219]
    v_perm_b32 v32, v58, v58, v4
    v_perm_b32 v33, v58, v58, v5
    v_perm_b32 v34, v58, v58, v6
    v_perm_b32 v35, v58, v58, v7
    v_perm_b32 v176, v202, v202, v4
    v_perm_b32 v177, v202, v202, v5
    v_perm_b32 v178, v202, v202, v6
    v_perm_b32 v179, v202, v202, v7
    v_add_f32 v192, v192, v196
    v_add_f32 v193, v193, v197
    v_add_f32 v194, v194, v198
    v_add_f32 v195, v195, v199
    v_add_f32 v192, v192, v194
    v_add_f32 v193, v193, v195
    v_add_f32 v192, v192, v193
    v_add_f32 v213, v213, v192
    s_waitcnt vmcnt(5)
    buffer_load_dwordx4 v[72:75], v236, s[12:15], s20 offen offset:2048 nt
    v_mfma_f32_16x16x32_bf16 v[60:63], v[32:35], v[80:83], v[60:63]
    v_mfma_f32_16x16x32_bf16 v[216:219], v[176:179], v[80:83], v[216:219]
    v_perm_b32 v36, v58, v58, v8
    v_perm_b32 v37, v58, v58, v9
    v_perm_b32 v38, v58, v58, v10
    v_perm_b32 v39, v58, v58, v11
    v_perm_b32 v180, v202, v202, v8
    v_perm_b32 v181, v202, v202, v9
    v_perm_b32 v182, v202, v202, v10
    v_perm_b32 v183, v202, v202, v11
    s_waitcnt vmcnt(5)
    buffer_load_dwordx4 v[76:79], v236, s[12:15], s20 offen offset:3072 nt
    v_mfma_f32_16x16x32_bf16 v[60:63], v[36:39], v[84:87], v[60:63]
    v_mfma_f32_16x16x32_bf16 v[216:219], v[180:183], v[84:87], v[216:219]
    v_perm_b32 v40, v59, v59, v4
    v_perm_b32 v41, v59, v59, v5
    v_perm_b32 v42, v59, v59, v6
    v_perm_b32 v43, v59, v59, v7
    v_perm_b32 v184, v203, v203, v4
    v_perm_b32 v185, v203, v203, v5
    v_perm_b32 v186, v203, v203, v6
    v_perm_b32 v187, v203, v203, v7
    s_waitcnt vmcnt(5)
    buffer_load_dwordx4 v[80:83], v237, s[16:19], s21 offen offset:0 nt
    v_mfma_f32_16x16x32_bf16 v[60:63], v[40:43], v[88:91], v[60:63]
    v_mfma_f32_16x16x32_bf16 v[216:219], v[184:187], v[88:91], v[216:219]
    v_perm_b32 v44, v59, v59, v8
    v_perm_b32 v45, v59, v59, v9
    v_perm_b32 v46, v59, v59, v10
    v_perm_b32 v47, v59, v59, v11
    v_perm_b32 v188, v203, v203, v8
    v_perm_b32 v189, v203, v203, v9
    v_perm_b32 v190, v203, v203, v10
    v_perm_b32 v191, v203, v203, v11
    s_waitcnt vmcnt(5)
    buffer_load_dwordx4 v[84:87], v237, s[16:19], s21 offen offset:1024 nt
    v_mfma_f32_16x16x32_bf16 v[60:63], v[44:47], v[92:95], v[60:63]
    v_mfma_f32_16x16x32_bf16 v[216:219], v[188:191], v[92:95], v[216:219]
    s_mov_b32 s40, s41
    s_nop 6
    s_branch L_B
L_F:
    s_xor_b32 s22, s40, s45
    s_and_b32 s22, s22, 0xfc
    s_cbranch_scc1 L_PH
L_FG:
    s_mov_b64 exec, 1
    ds_add_rtn_u32 v229, v235, v234 offset:4128
    s_mov_b64 exec, -1
    s_add_u32 s47, s47, 1
    s_waitcnt vmcnt(5)
    buffer_load_dwordx4 v[88:91], v237, s[16:19], s21 offen offset:2048 nt
    s_waitcnt lgkmcnt(0)
    s_mov_b64 exec, 1
    ds_read_b32 v230, v229
    s_mov_b64 exec, -1
    v_mfma_f32_16x16x32_bf16 v[16:19], v[64:67], v[12:15], 0
    s_waitcnt vmcnt(5)
    buffer_load_dwordx4 v[92:95], v237, s[16:19], s21 offen offset:3072 nt
    s_waitcnt lgkmcnt(0)
L_FC:
    v_readfirstlane_b32 s41, v230
    s_bitcmp1_b32 s41, 0
    s_cbranch_scc0 L_SPF
    s_and_b32 s20, s41, 0xfffff000
    s_bitcmp1_b32 s41, 6
    s_cselect_b64 s[50:51], s[32:33], s[28:29]
    s_cselect_b64 s[52:53], s[34:35], s[30:31]
    s_cselect_b32 s14, s37, s36
    s_bitcmp1_b32 s41, 3
    s_cselect_b64 s[12:13], s[52:53], s[50:51]
    s_cselect_b64 s[54:55], -1, 0
    v_cndmask_b32 v236, v1, v2, s[54:55]
    s_and_b32 s22, s41, 1024
    s_lshl_b32 s22, s22, 4
    s_xor_b32 s21, s22, s20
    s_mov_b32 s18, s14
    s_bitcmp1_b32 s41, 2
    s_cselect_b64 s[16:17], s[50:51], s[52:53]
    s_cselect_b64 s[56:57], -1, 0
    v_cndmask_b32 v237, v2, v1, s[56:57]
    s_bitcmp1_b32 s41, 1
    s_cbranch_scc1 L_FX
    v_mfma_f32_16x16x32_bf16 v[20:23], v[68:71], v[12:15], 0
    s_waitcnt vmcnt(5)
    buffer_load_dwordx4 v[64:67], v236, s[12:15], s20 offen offset:0 nt
    v_mfma_f32_16x16x32_bf16 v[24:27], v[72:75], v[12:15], 0
    v_mov_b32_dpp v48, v16 quad_perm:[0,0,0,0] row_mask:0xf bank_mask:0xf
    s_nop 3
    v_mov_b32_dpp v49, v20 quad_perm:[0,0,0,0] row_mask:0xf bank_mask:0xf
    v_add_f32_dpp v48, v17, v48 quad_perm:[1,1,1,1] row_mask:0xf bank_mask:0xf
    s_nop 0
    v_add_f32_dpp v49, v21, v49 quad_perm:[1,1,1,1] row_mask:0xf bank_mask:0xf
    v_add_f32_dpp v48, v18, v48 quad_perm:[2,2,2,2] row_mask:0xf bank_mask:0xf
    s_nop 0
    v_add_f32_dpp v49, v22, v49 quad_perm:[2,2,2,2] row_mask:0xf bank_mask:0xf
    v_add_f32_dpp v48, v19, v48 quad_perm:[3,3,3,3] row_mask:0xf bank_mask:0xf
    s_nop 0
    v_add_f32_dpp v49, v23, v49 quad_perm:[3,3,3,3] row_mask:0xf bank_mask:0xf
    v_cvt_pk_bf16_f32 v56, v48, v49
    v_lshlrev_b32 v48, 16, v56
    v_and_b32 v49, 0xffff0000, v56
    v_mul_f32 v48, 0x3db504f3, v48
    v_mul_f32 v49, 0x3db504f3, v49
    v_cvt_pk_bf16_f32 v56, v48, v49
    v_lshlrev_b32 v48, 16, v56
    v_and_b32 v49, 0xffff0000, v56
    s_waitcnt vmcnt(5)
    buffer_load_dwordx4 v[68:71], v236, s[12:15], s20 offen offset:1024 nt
    v_mfma_f32_16x16x32_bf16 v[28:31], v[76:79], v[12:15], 0
    v_mov_b32_dpp v50, v24 quad_perm:[0,0,0,0] row_mask:0xf bank_mask:0xf
    s_nop 6
    v_mov_b32_dpp v51, v28 quad_perm:[0,0,0,0] row_mask:0xf bank_mask:0xf
    v_add_f32_dpp v50, v25, v50 quad_perm:[1,1,1,1] row_mask:0xf bank_mask:0xf
    s_nop 0
    v_add_f32_dpp v51, v29, v51 quad_perm:[1,1,1,1] row_mask:0xf bank_mask:0xf
    v_add_f32_dpp v50, v26, v50 quad_perm:[2,2,2,2] row_mask:0xf bank_mask:0xf
    s_nop 0
    v_add_f32_dpp v51, v30, v51 quad_perm:[2,2,2,2] row_mask:0xf bank_mask:0xf
    v_add_f32_dpp v50, v27, v50 quad_perm:[3,3,3,3] row_mask:0xf bank_mask:0xf
    s_nop 0
    v_add_f32_dpp v51, v31, v51 quad_perm:[3,3,3,3] row_mask:0xf bank_mask:0xf
    v_cvt_pk_bf16_f32 v57, v50, v51
    v_lshlrev_b32 v50, 16, v57
    v_and_b32 v51, 0xffff0000, v57
    v_mul_f32 v50, 0x3db504f3, v50
    v_mul_f32 v51, 0x3db504f3, v51
    v_cvt_pk_bf16_f32 v57, v50, v51
    v_lshlrev_b32 v50, 16, v57
    v_and_b32 v51, 0xffff0000, v57
    v_max3_f32 v248, v48, v49, v50
    v_max_f32 v248, v248, v51
    v_cmp_gt_f32 vcc, v248, v244
    s_cbranch_vccnz SLOW_1
BACK_2:
    s_waitcnt vmcnt(5)
    buffer_load_dwordx4 v[72:75], v236, s[12:15], s20 offen offset:2048 nt
    v_fma_f32 v48, v48, s75, v245
    v_fma_f32 v49, v49, s75, v245
    v_fma_f32 v50, v50, s75, v245
    v_fma_f32 v51, v51, s75, v245
    v_exp_f32 v48, v48
    v_exp_f32 v49, v49
    v_exp_f32 v50, v50
    v_exp_f32 v51, v51
    v_cvt_pk_bf16_f32 v56, v48, v49
    v_cvt_pk_bf16_f32 v57, v50, v51
    v_perm_b32 v16, v56, v56, v4
    v_perm_b32 v17, v56, v56, v5
    v_perm_b32 v18, v56, v56, v6
    v_perm_b32 v19, v56, v56, v7
    v_perm_b32 v20, v56, v56, v8
    v_perm_b32 v21, v56, v56, v9
    v_perm_b32 v22, v56, v56, v10
    v_perm_b32 v23, v56, v56, v11
    s_waitcnt vmcnt(5)
    buffer_load_dwordx4 v[76:79], v236, s[12:15], s20 offen offset:3072 nt
    v_mfma_f32_16x16x32_bf16 v[60:63], v[16:19], v[80:83], v[60:63]
    v_mfma_f32_16x16x32_bf16 v[60:63], v[20:23], v[84:87], v[60:63]
    v_perm_b32 v24, v57, v57, v4
    v_perm_b32 v25, v57, v57, v5
    v_perm_b32 v26, v57, v57, v6
    v_perm_b32 v27, v57, v57, v7
    v_perm_b32 v28, v57, v57, v8
    v_perm_b32 v29, v57, v57, v9
    v_perm_b32 v30, v57, v57, v10
    v_perm_b32 v31, v57, v57, v11
    v_add_f32 v48, v48, v50
    v_add_f32 v49, v49, v51
    v_add_f32 v48, v48, v49
    v_add_f32 v246, v246, v48
    s_waitcnt vmcnt(5)
    buffer_load_dwordx4 v[80:83], v237, s[16:19], s21 offen offset:0 nt
    v_mfma_f32_16x16x32_bf16 v[60:63], v[24:27], v[88:91], v[60:63]
    s_waitcnt vmcnt(5)
    buffer_load_dwordx4 v[84:87], v237, s[16:19], s21 offen offset:1024 nt
    v_mfma_f32_16x16x32_bf16 v[60:63], v[28:31], v[92:95], v[60:63]
    s_mov_b32 s40, s41
    s_nop 6
    s_branch L_F
L_FX:
    buffer_load_dwordx4 v[96:99], v236, s[12:15], s20 offen offset:0 nt
    buffer_load_dwordx4 v[100:103], v236, s[12:15], s20 offen offset:1024 nt
    buffer_load_dwordx4 v[104:107], v236, s[12:15], s20 offen offset:2048 nt
    buffer_load_dwordx4 v[108:111], v236, s[12:15], s20 offen offset:3072 nt
    buffer_load_dwordx4 v[112:115], v237, s[16:19], s21 offen offset:0 nt
    buffer_load_dwordx4 v[116:119], v237, s[16:19], s21 offen offset:1024 nt
    buffer_load_dwordx4 v[120:123], v237, s[16:19], s21 offen offset:2048 nt
    buffer_load_dwordx4 v[124:127], v237, s[16:19], s21 offen offset:3072 nt
    v_mfma_f32_16x16x32_bf16 v[20:23], v[68:71], v[12:15], 0
    s_waitcnt vmcnt(13)
    v_mfma_f32_16x16x32_bf16 v[24:27], v[72:75], v[12:15], 0
    v_mov_b32_dpp v48, v16 quad_perm:[0,0,0,0] row_mask:0xf bank_mask:0xf
    s_nop 4
    v_mov_b32_dpp v49, v20 quad_perm:[0,0,0,0] row_mask:0xf bank_mask:0xf
    v_add_f32_dpp v48, v17, v48 quad_perm:[1,1,1,1] row_mask:0xf bank_mask:0xf
    s_nop 0
    v_add_f32_dpp v49, v21, v49 quad_perm:[1,1,1,1] row_mask:0xf bank_mask:0xf
    v_add_f32_dpp v48, v18, v48 quad_perm:[2,2,2,2] row_mask:0xf bank_mask:0xf
    s_nop 0
    v_add_f32_dpp v49, v22, v49 quad_perm:[2,2,2,2] row_mask:0xf bank_mask:0xf
    v_add_f32_dpp v48, v19, v48 quad_perm:[3,3,3,3] row_mask:0xf bank_mask:0xf
    s_nop 0
    v_add_f32_dpp v49, v23, v49 quad_perm:[3,3,3,3] row_mask:0xf bank_mask:0xf
    v_cvt_pk_bf16_f32 v56, v48, v49
    v_lshlrev_b32 v48, 16, v56
    v_and_b32 v49, 0xffff0000, v56
    v_mul_f32 v48, 0x3db504f3, v48
    v_mul_f32 v49, 0x3db504f3, v49
    v_cvt_pk_bf16_f32 v56, v48, v49
    v_lshlrev_b32 v48, 16, v56
    v_and_b32 v49, 0xffff0000, v56
    s_waitcnt vmcnt(12)
    v_mfma_f32_16x16x32_bf16 v[28:31], v[76:79], v[12:15], 0
    v_mov_b32_dpp v50, v24 quad_perm:[0,0,0,0] row_mask:0xf bank_mask:0xf
    s_nop 6
    v_mov_b32_dpp v51, v28 quad_perm:[0,0,0,0] row_mask:0xf bank_mask:0xf
    v_add_f32_dpp v50, v25, v50 quad_perm:[1,1,1,1] row_mask:0xf bank_mask:0xf
    s_nop 0
    v_add_f32_dpp v51, v29, v51 quad_perm:[1,1,1,1] row_mask:0xf bank_mask:0xf
    v_add_f32_dpp v50, v26, v50 quad_perm:[2,2,2,2] row_mask:0xf bank_mask:0xf
    s_nop 0
    v_add_f32_dpp v51, v30, v51 quad_perm:[2,2,2,2] row_mask:0xf bank_mask:0xf
    v_add_f32_dpp v50, v27, v50 quad_perm:[3,3,3,3] row_mask:0xf bank_mask:0xf
    s_nop 0
    v_add_f32_dpp v51, v31, v51 quad_perm:[3,3,3,3] row_mask:0xf bank_mask:0xf
    v_cvt_pk_bf16_f32 v57, v50, v51
    v_lshlrev_b32 v50, 16, v57
    v_and_b32 v51, 0xffff0000, v57
    v_mul_f32 v50, 0x3db504f3, v50
    v_mul_f32 v51, 0x3db504f3, v51
    v_cvt_pk_bf16_f32 v57, v50, v51
    v_lshlrev_b32 v50, 16, v57
    v_and_b32 v51, 0xffff0000, v57
    v_max3_f32 v248, v48, v49, v50
    v_max_f32 v248, v248, v51
    v_cmp_gt_f32 vcc, v248, v244
    s_cbranch_vccnz SLOW_3
BACK_4:
    s_waitcnt vmcnt(11)
    v_fma_f32 v48, v48, s75, v245
    v_fma_f32 v49, v49, s75, v245
    v_fma_f32 v50, v50, s75, v245
    v_fma_f32 v51, v51, s75, v245
    v_exp_f32 v48, v48
    v_exp_f32 v49, v49
    v_exp_f32 v50, v50
    v_exp_f32 v51, v51
    v_cvt_pk_bf16_f32 v56, v48, v49
    v_cvt_pk_bf16_f32 v57, v50, v51
    v_perm_b32 v16, v56, v56, v4
    v_perm_b32 v17, v56, v56, v5
    v_perm_b32 v18, v56, v56, v6
    v_perm_b32 v19, v56, v56, v7
    v_perm_b32 v20, v56, v56, v8
    v_perm_b32 v21, v56, v56, v9
    v_perm_b32 v22, v56, v56, v10
    v_perm_b32 v23, v56, v56, v11
    s_waitcnt vmcnt(10)
    v_mfma_f32_16x16x32_bf16 v[60:63], v[16:19], v[80:83], v[60:63]
    v_mfma_f32_16x16x32_bf16 v[60:63], v[20:23], v[84:87], v[60:63]
    v_perm_b32 v24, v57, v57, v4
    v_perm_b32 v25, v57, v57, v5
    v_perm_b32 v26, v57, v57, v6
    v_perm_b32 v27, v57, v57, v7
    v_perm_b32 v28, v57, v57, v8
    v_perm_b32 v29, v57, v57, v9
    v_perm_b32 v30, v57, v57, v10
    v_perm_b32 v31, v57, v57, v11
    v_add_f32 v48, v48, v50
    v_add_f32 v49, v49, v51
    v_add_f32 v48, v48, v49
    v_add_f32 v246, v246, v48
    s_waitcnt vmcnt(9)
    v_mfma_f32_16x16x32_bf16 v[60:63], v[24:27], v[88:91], v[60:63]
    s_waitcnt vmcnt(8)
    v_mfma_f32_16x16x32_bf16 v[60:63], v[28:31], v[92:95], v[60:63]
    s_mov_b32 s40, s41
    s_nop 6
    s_branch L_G1
L_G0:
    s_xor_b32 s22, s40, s45
    s_and_b32 s22, s22, 0xfc
    s_cbranch_scc1 L_PH
L_G0G:
    s_mov_b64 exec, 1
    ds_add_rtn_u32 v229, v235, v234 offset:4128
    s_mov_b64 exec, -1
    s_add_u32 s47, s47, 1
    s_waitcnt lgkmcnt(0)
    s_mov_b64 exec, 1
    ds_read_b32 v230, v229
    s_mov_b64 exec, -1
    s_waitcnt lgkmcnt(0)
    v_readfirstlane_b32 s41, v230
    s_bitcmp1_b32 s41, 0
    s_cselect_b32 s20, s41, 0xf0000000
    s_and_b32 s20, s20, 0xfffff000
    s_mov_b32 s21, s20
    buffer_load_dwordx4 v[96:99], v236, s[12:15], s20 offen offset:0 nt
    buffer_load_dwordx4 v[100:103], v236, s[12:15], s20 offen offset:1024 nt
    buffer_load_dwordx4 v[104:107], v236, s[12:15], s20 offen offset:2048 nt
    buffer_load_dwordx4 v[108:111], v236, s[12:15], s20 offen offset:3072 nt
    buffer_load_dwordx4 v[112:115], v237, s[16:19], s21 offen offset:0 nt
    buffer_load_dwordx4 v[116:119], v237, s[16:19], s21 offen offset:1024 nt
    buffer_load_dwordx4 v[120:123], v237, s[16:19], s21 offen offset:2048 nt
    buffer_load_dwordx4 v[124:127], v237, s[16:19], s21 offen offset:3072 nt
    s_waitcnt vmcnt(15)
    v_mfma_f32_16x16x32_bf16 v[16:19], v[64:67], v[12:15], 0
    s_waitcnt vmcnt(14)
    v_mfma_f32_16x16x32_bf16 v[20:23], v[68:71], v[12:15], 0
    s_waitcnt vmcnt(13)
    v_mfma_f32_16x16x32_bf16 v[24:27], v[72:75], v[12:15], 0
    s_nop 3
    v_mov_b32_dpp v48, v16 quad_perm:[0,0,0,0] row_mask:0xf bank_mask:0xf
    s_nop 0
    v_mov_b32_dpp v49, v20 quad_perm:[0,0,0,0] row_mask:0xf bank_mask:0xf
    v_add_f32_dpp v48, v17, v48 quad_perm:[1,1,1,1] row_mask:0xf bank_mask:0xf
    s_nop 0
    v_add_f32_dpp v49, v21, v49 quad_perm:[1,1,1,1] row_mask:0xf bank_mask:0xf
    v_add_f32_dpp v48, v18, v48 quad_perm:[2,2,2,2] row_mask:0xf bank_mask:0xf
    s_nop 0
    v_add_f32_dpp v49, v22, v49 quad_perm:[2,2,2,2] row_mask:0xf bank_mask:0xf
    v_add_f32_dpp v48, v19, v48 quad_perm:[3,3,3,3] row_mask:0xf bank_mask:0xf
    s_nop 0
    v_add_f32_dpp v49, v23, v49 quad_perm:[3,3,3,3] row_mask:0xf bank_mask:0xf
    v_cvt_pk_bf16_f32 v56, v48, v49
    v_lshlrev_b32 v48, 16, v56
    v_and_b32 v49, 0xffff0000, v56
    v_mul_f32 v48, 0x3db504f3, v48
    v_mul_f32 v49, 0x3db504f3, v49
    v_cvt_pk_bf16_f32 v56, v48, v49
    v_lshlrev_b32 v48, 16, v56
    v_and_b32 v49, 0xffff0000, v56
    s_waitcnt vmcnt(12)
    v_mfma_f32_16x16x32_bf16 v[28:31], v[76:79], v[12:15], 0
    v_mov_b32_dpp v50, v24 quad_perm:[0,0,0,0] row_mask:0xf bank_mask:0xf
    s_nop 6
    v_mov_b32_dpp v51, v28 quad_perm:[0,0,0,0] row_mask:0xf bank_mask:0xf
    v_add_f32_dpp v50, v25, v50 quad_perm:[1,1,1,1] row_mask:0xf bank_mask:0xf
    s_nop 0
    v_add_f32_dpp v51, v29, v51 quad_perm:[1,1,1,1] row_mask:0xf bank_mask:0xf
    v_add_f32_dpp v50, v26, v50 quad_perm:[2,2,2,2] row_mask:0xf bank_mask:0xf
    s_nop 0
    v_add_f32_dpp v51, v30, v51 quad_perm:[2,2,2,2] row_mask:0xf bank_mask:0xf
    v_add_f32_dpp v50, v27, v50 quad_perm:[3,3,3,3] row_mask:0xf bank_mask:0xf
    s_nop 0
    v_add_f32_dpp v51, v31, v51 quad_perm:[3,3,3,3] row_mask:0xf bank_mask:0xf
    v_cvt_pk_bf16_f32 v57, v50, v51
    v_lshlrev_b32 v50, 16, v57
    v_and_b32 v51, 0xffff0000, v57
    v_mul_f32 v50, 0x3db504f3, v50
    v_mul_f32 v51, 0x3db504f3, v51
    v_cvt_pk_bf16_f32 v57, v50, v51
    v_lshlrev_b32 v50, 16, v57
    v_and_b32 v51, 0xffff0000, v57
    v_max3_f32 v248, v48, v49, v50
    v_max_f32 v248, v248, v51
    v_cmp_gt_f32 vcc, v248, v244
    s_cbranch_vccnz SLOW_5
BACK_6:
    s_waitcnt vmcnt(11)
    v_fma_f32 v48, v48, s75, v245
    v_fma_f32 v49, v49, s75, v245
    v_fma_f32 v50, v50, s75, v245
    v_fma_f32 v51, v51, s75, v245
    v_exp_f32 v48, v48
    v_exp_f32 v49, v49
    v_exp_f32 v50, v50
    v_exp_f32 v51, v51
    v_cvt_pk_bf16_f32 v56, v48, v49
    v_cvt_pk_bf16_f32 v57, v50, v51
    v_perm_b32 v16, v56, v56, v4
    v_perm_b32 v17, v56, v56, v5
    v_perm_b32 v18, v56, v56, v6
    v_perm_b32 v19, v56, v56, v7
    v_perm_b32 v20, v56, v56, v8
    v_perm_b32 v21, v56, v56, v9
    v_perm_b32 v22, v56, v56, v10
    v_perm_b32 v23, v56, v56, v11
    s_waitcnt vmcnt(10)
    v_mfma_f32_16x16x32_bf16 v[60:63], v[16:19], v[80:83], v[60:63]
    v_mfma_f32_16x16x32_bf16 v[60:63], v[20:23], v[84:87], v[60:63]
    v_perm_b32 v24, v57, v57, v4
    v_perm_b32 v25, v57, v57, v5
    v_perm_b32 v26, v57, v57, v6
    v_perm_b32 v27, v57, v57, v7
    v_perm_b32 v28, v57, v57, v8
    v_perm_b32 v29, v57, v57, v9
    v_perm_b32 v30, v57, v57, v10
    v_perm_b32 v31, v57, v57, v11
    v_add_f32 v48, v48, v50
    v_add_f32 v49, v49, v51
    v_add_f32 v48, v48, v49
    v_add_f32 v246, v246, v48
    s_waitcnt vmcnt(9)
    v_mfma_f32_16x16x32_bf16 v[60:63], v[24:27], v[88:91], v[60:63]
    s_waitcnt vmcnt(8)
    v_mfma_f32_16x16x32_bf16 v[60:63], v[28:31], v[92:95], v[60:63]
    s_mov_b32 s40, s41
    s_bitcmp1_b32 s41, 0
    s_nop 5
    s_cbranch_scc1 L_G1
    s_waitcnt lgkmcnt(0)
    s_mov_b64 exec, 1
    ds_read_b32 v230, v229
    s_mov_b64 exec, -1
    s_waitcnt lgkmcnt(0)
L_G0C:
    v_readfirstlane_b32 s41, v230
    s_bitcmp1_b32 s41, 0
    s_cbranch_scc0 L_SPG0
    s_and_b32 s20, s41, 0xfffff000
    s_bitcmp1_b32 s41, 6
    s_cselect_b64 s[50:51], s[32:33], s[28:29]
    s_cselect_b64 s[52:53], s[34:35], s[30:31]
    s_cselect_b32 s14, s37, s36
    s_bitcmp1_b32 s41, 3
    s_cselect_b64 s[12:13], s[52:53], s[50:51]
    s_cselect_b64 s[54:55], -1, 0
    v_cndmask_b32 v236, v1, v2, s[54:55]
    s_mov_b32 s21, s20
    buffer_load_dwordx4 v[96:99], v236, s[12:15], s20 offen offset:0 nt
    buffer_load_dwordx4 v[100:103], v236, s[12:15], s20 offen offset:1024 nt
    buffer_load_dwordx4 v[104:107], v236, s[12:15], s20 offen offset:2048 nt
    buffer_load_dwordx4 v[108:111], v236, s[12:15], s20 offen offset:3072 nt
    buffer_load_dwordx4 v[112:115], v237, s[16:19], s21 offen offset:0 nt
    buffer_load_dwordx4 v[116:119], v237, s[16:19], s21 offen offset:1024 nt
    buffer_load_dwordx4 v[120:123], v237, s[16:19], s21 offen offset:2048 nt
    buffer_load_dwordx4 v[124:127], v237, s[16:19], s21 offen offset:3072 nt
    s_mov_b32 s40, s41
    s_branch L_G1
L_G1:
    s_xor_b32 s22, s40, s45
    s_and_b32 s22, s22, 0xfc
    s_cbranch_scc1 L_PH
L_G1G:
    s_mov_b64 exec, 1
    ds_add_rtn_u32 v229, v235, v234 offset:4128
    s_mov_b64 exec, -1
    s_add_u32 s47, s47, 1
    s_waitcnt lgkmcnt(0)
    s_mov_b64 exec, 1
    ds_read_b32 v230, v229
    s_mov_b64 exec, -1
    s_waitcnt lgkmcnt(0)
    v_readfirstlane_b32 s41, v230
    s_bitcmp1_b32 s41, 0
    s_cselect_b32 s20, s41, 0xf0000000
    s_and_b32 s20, s20, 0xfffff000
    s_mov_b32 s21, s20
    buffer_load_dwordx4 v[64:67], v236, s[12:15], s20 offen offset:0 nt
    buffer_load_dwordx4 v[68:71], v236, s[12:15], s20 offen offset:1024 nt
    buffer_load_dwordx4 v[72:75], v236, s[12:15], s20 offen offset:2048 nt
    buffer_load_dwordx4 v[76:79], v236, s[12:15], s20 offen offset:3072 nt
    buffer_load_dwordx4 v[80:83], v237, s[16:19], s21 offen offset:0 nt
    buffer_load_dwordx4 v[84:87], v237, s[16:19], s21 offen offset:1024 nt
    buffer_load_dwordx4 v[88:91], v237, s[16:19], s21 offen offset:2048 nt
    buffer_load_dwordx4 v[92:95], v237, s[16:19], s21 offen offset:3072 nt
    s_waitcnt vmcnt(15)
    v_mfma_f32_16x16x32_bf16 v[16:19], v[96:99], v[12:15], 0
    s_waitcnt vmcnt(14)
    v_mfma_f32_16x16x32_bf16 v[20:23], v[100:103], v[12:15], 0
    s_waitcnt vmcnt(13)
    v_mfma_f32_16x16x32_bf16 v[24:27], v[104:107], v[12:15], 0
    s_nop 3
    v_mov_b32_dpp v48, v16 quad_perm:[0,0,0,0] row_mask:0xf bank_mask:0xf
    s_nop 0
    v_mov_b32_dpp v49, v20 quad_perm:[0,0,0,0] row_mask:0xf bank_mask:0xf
    v_add_f32_dpp v48, v17, v48 quad_perm:[1,1,1,1] row_mask:0xf bank_mask:0xf
    s_nop 0
    v_add_f32_dpp v49, v21, v49 quad_perm:[1,1,1,1] row_mask:0xf bank_mask:0xf
    v_add_f32_dpp v48, v18, v48 quad_perm:[2,2,2,2] row_mask:0xf bank_mask:0xf
    s_nop 0
    v_add_f32_dpp v49, v22, v49 quad_perm:[2,2,2,2] row_mask:0xf bank_mask:0xf
    v_add_f32_dpp v48, v19, v48 quad_perm:[3,3,3,3] row_mask:0xf bank_mask:0xf
    s_nop 0
    v_add_f32_dpp v49, v23, v49 quad_perm:[3,3,3,3] row_mask:0xf bank_mask:0xf
    v_cvt_pk_bf16_f32 v56, v48, v49
    v_lshlrev_b32 v48, 16, v56
    v_and_b32 v49, 0xffff0000, v56
    v_mul_f32 v48, 0x3db504f3, v48
    v_mul_f32 v49, 0x3db504f3, v49
    v_cvt_pk_bf16_f32 v56, v48, v49
    v_lshlrev_b32 v48, 16, v56
    v_and_b32 v49, 0xffff0000, v56
    s_waitcnt vmcnt(12)
    v_mfma_f32_16x16x32_bf16 v[28:31], v[108:111], v[12:15], 0
    v_mov_b32_dpp v50, v24 quad_perm:[0,0,0,0] row_mask:0xf bank_mask:0xf
    s_nop 6
    v_mov_b32_dpp v51, v28 quad_perm:[0,0,0,0] row_mask:0xf bank_mask:0xf
    v_add_f32_dpp v50, v25, v50 quad_perm:[1,1,1,1] row_mask:0xf bank_mask:0xf
    s_nop 0
    v_add_f32_dpp v51, v29, v51 quad_perm:[1,1,1,1] row_mask:0xf bank_mask:0xf
    v_add_f32_dpp v50, v26, v50 quad_perm:[2,2,2,2] row_mask:0xf bank_mask:0xf
    s_nop 0
    v_add_f32_dpp v51, v30, v51 quad_perm:[2,2,2,2] row_mask:0xf bank_mask:0xf
    v_add_f32_dpp v50, v27, v50 quad_perm:[3,3,3,3] row_mask:0xf bank_mask:0xf
    s_nop 0
    v_add_f32_dpp v51, v31, v51 quad_perm:[3,3,3,3] row_mask:0xf bank_mask:0xf
    v_cvt_pk_bf16_f32 v57, v50, v51
    v_lshlrev_b32 v50, 16, v57
    v_and_b32 v51, 0xffff0000, v57
    v_mul_f32 v50, 0x3db504f3, v50
    v_mul_f32 v51, 0x3db504f3, v51
    v_cvt_pk_bf16_f32 v57, v50, v51
    v_lshlrev_b32 v50, 16, v57
    v_and_b32 v51, 0xffff0000, v57
    v_max3_f32 v248, v48, v49, v50
    v_max_f32 v248, v248, v51
    v_cmp_gt_f32 vcc, v248, v244
    s_cbranch_vccnz SLOW_7
BACK_8:
    s_waitcnt vmcnt(11)
    v_fma_f32 v48, v48, s75, v245
    v_fma_f32 v49, v49, s75, v245
    v_fma_f32 v50, v50, s75, v245
    v_fma_f32 v51, v51, s75, v245
    v_exp_f32 v48, v48
    v_exp_f32 v49, v49
    v_exp_f32 v50, v50
    v_exp_f32 v51, v51
    v_cvt_pk_bf16_f32 v56, v48, v49
    v_cvt_pk_bf16_f32 v57, v50, v51
    v_perm_b32 v16, v56, v56, v4
    v_perm_b32 v17, v56, v56, v5
    v_perm_b32 v18, v56, v56, v6
    v_perm_b32 v19, v56, v56, v7
    v_perm_b32 v20, v56, v56, v8
    v_perm_b32 v21, v56, v56, v9
    v_perm_b32 v22, v56, v56, v10
    v_perm_b32 v23, v56, v56, v11
    s_waitcnt vmcnt(10)
    v_mfma_f32_16x16x32_bf16 v[60:63], v[16:19], v[112:115], v[60:63]
    v_mfma_f32_16x16x32_bf16 v[60:63], v[20:23], v[116:119], v[60:63]
    v_perm_b32 v24, v57, v57, v4
    v_perm_b32 v25, v57, v57, v5
    v_perm_b32 v26, v57, v57, v6
    v_perm_b32 v27, v57, v57, v7
    v_perm_b32 v28, v57, v57, v8
    v_perm_b32 v29, v57, v57, v9
    v_perm_b32 v30, v57, v57, v10
    v_perm_b32 v31, v57, v57, v11
    v_add_f32 v48, v48, v50
    v_add_f32 v49, v49, v51
    v_add_f32 v48, v48, v49
    v_add_f32 v246, v246, v48
    s_waitcnt vmcnt(9)
    v_mfma_f32_16x16x32_bf16 v[60:63], v[24:27], v[120:123], v[60:63]
    s_waitcnt vmcnt(8)
    v_mfma_f32_16x16x32_bf16 v[60:63], v[28:31], v[124:127], v[60:63]
    s_mov_b32 s40, s41
    s_bitcmp1_b32 s41, 0
    s_nop 5
    s_cbranch_scc1 L_G0
    s_waitcnt lgkmcnt(0)
    s_mov_b64 exec, 1
    ds_read_b32 v230, v229
    s_mov_b64 exec, -1
    s_waitcnt lgkmcnt(0)
L_G1C:
    v_readfirstlane_b32 s41, v230
    s_bitcmp1_b32 s41, 0
    s_cbranch_scc0 L_SPG1
    s_and_b32 s20, s41, 0xfffff000
    s_bitcmp1_b32 s41, 6
    s_cselect_b64 s[50:51], s[32:33], s[28:29]
    s_cselect_b64 s[52:53], s[34:35], s[30:31]
    s_cselect_b32 s14, s37, s36
    s_bitcmp1_b32 s41, 3
    s_cselect_b64 s[12:13], s[52:53], s[50:51]
    s_cselect_b64 s[54:55], -1, 0
    v_cndmask_b32 v236, v1, v2, s[54:55]
    s_mov_b32 s21, s20
    buffer_load_dwordx4 v[64:67], v236, s[12:15], s20 offen offset:0 nt
    buffer_load_dwordx4 v[68:71], v236, s[12:15], s20 offen offset:1024 nt
    buffer_load_dwordx4 v[72:75], v236, s[12:15], s20 offen offset:2048 nt
    buffer_load_dwordx4 v[76:79], v236, s[12:15], s20 offen offset:3072 nt
    buffer_load_dwordx4 v[80:83], v237, s[16:19], s21 offen offset:0 nt
    buffer_load_dwordx4 v[84:87], v237, s[16:19], s21 offen offset:1024 nt
    buffer_load_dwordx4 v[88:91], v237, s[16:19], s21 offen offset:2048 nt
    buffer_load_dwordx4 v[92:95], v237, s[16:19], s21 offen offset:3072 nt
    s_mov_b32 s40, s41
    s_branch L_G0
L_PH:
    s_mov_b32 s46, s40
    s_nop 7
    v_mov_b32 v230, s47
    s_bfe_u32 s22, s45, 0x30004
    s_bitcmp1_b32 s45, 2
    s_cbranch_scc1 L_PHK
    s_bitcmp1_b32 s45, 6
    s_cbranch_scc1 L_PHB
    s_and_b32 s23, s46, 0xfc
    s_lshl_b32 s23, s23, 8
    s_or_b32 s23, s23, s45
    s_cmp_eq_u32 s23, 0x3038
    s_cbranch_scc1 L_PHVF
    s_mul_i32 s23, s22, 2176
    s_lshl_b32 s22, s22, 2
    v_add_u32 v16, s23, v226
    v_add_u32 v17, s23, v225
    v_add_u32 v18, s23, v224
    v_mov_b32 v19, s22
    ds_write_b32 v16, v246
    ds_write_b32 v17, v244
    ds_write_b128 v18, v[60:63]
    ds_add_u32 v19, v230 offset:4096
    s_branch L_PHN
L_PHK:
    s_lshl_b32 s23, s22, 4
    s_lshl_b32 s22, s22, 2
    v_add_u32 v16, s23, v242
    v_mov_b32 v17, s22
    ds_max_f32 v16, v244 offset:4256
    ds_add_u32 v17, v230 offset:4224
    s_branch L_PHN
L_PHB:
    ds_write_b32 v233, v246 offset:8704
    ds_write_b32 v232, v244 offset:8704
    ds_write_b32 v233, v213 offset:13056
    ds_write_b32 v232, v211 offset:13056
    ds_write_b128 v231, v[60:63] offset:8704
    ds_write_b128 v231, v[216:219] offset:13056
    ds_add_u32 v235, v230 offset:4112
L_PHN:
    s_bitcmp1_b32 s46, 7
    s_cbranch_scc1 L_FINI
    s_and_b32 s45, s46, 0xfc
    s_mov_b32 s47, 0
    s_bfe_u32 s22, s46, 0x30004
    s_bitcmp1_b32 s46, 3
    s_cbranch_scc1 L_PHV
    s_lshl_b32 s23, s22, 8
    v_add_u32 v20, s23, v227
    v_add_u32 v21, s23, v228
    s_bitcmp1_b32 s46, 6
    s_cselect_b64 s[54:55], -1, 0
    v_cndmask_b32 v20, v20, v21, s[54:55]
    ds_read_b128 v[12:15], v20 offset:13312
    s_mul_i32 s23, s22, 0x2400
    s_and_b32 s23, s23, 0xc400
    s_add_u32 s23, s23, 40960
    v_add_u32 v238, s23, v240
    s_waitcnt lgkmcnt(0)
    v_mov_b32 v244, 0xff61b1e6
    s_bitcmp1_b32 s46, 2
    s_cbranch_scc0 L_PHF
    s_branch L_KG
L_PHF:
    v_mov_b32 v245, 0x7f61b1e6
    v_mov_b32 v246, 0
    v_mov_b32 v60, 0
    v_mov_b32 v61, 0
    v_mov_b32 v62, 0
    v_mov_b32 v63, 0
    s_nop 1
    s_branch L_FG
L_PHVF:
    s_and_b32 s45, s46, 0xfc
    s_mov_b32 s47, 0
    ds_read_b128 v[12:15], v227 offset:14080
    s_waitcnt lgkmcnt(0)
    s_branch L_FG
L_PHV:
    s_lshl_b32 s23, s22, 2
    v_mov_b32 v20, s23
    s_lshl_b32 s23, s22, 4
    v_add_u32 v21, s23, v242
    s_mul_i32 s23, s22, 0x2400
    s_and_b32 s23, s23, 0xc400
    s_add_u32 s23, s23, 40960
    v_add_u32 v238, s23, v240
    s_mov_b32 s23, 2048
    s_cmp_eq_u32 s22, 3
    s_cselect_b32 s23, 1280, s23
    s_cmp_eq_u32 s22, 4
    s_cselect_b32 s23, 512, s23
L_KW:
    ds_read_b32 v22, v20 offset:4224
    s_waitcnt lgkmcnt(0)
    v_readfirstlane_b32 s71, v22
    s_cmp_ge_u32 s71, s23
    s_cbranch_scc1 L_KWD
    s_sleep 1
    s_sub_u32 s70, s70, 1
    s_cbranch_scc0 L_KW
    s_mov_b32 s70, 0
L_KWD:
    s_bitcmp1_b32 s46, 6
    s_cbranch_scc1 L_PHVB
    ds_read_b32 v244, v21 offset:4256
    v_mov_b32 v246, 0
    v_mov_b32 v60, 0
    v_mov_b32 v61, 0
    v_mov_b32 v62, 0
    v_mov_b32 v63, 0
    s_waitcnt lgkmcnt(0)
    v_mul_f32 v245, s74, v244
    s_nop 1
    s_branch L_AG
L_PHVB:
    ds_read_b32 v244, v243 offset:4320
    ds_read_b32 v211, v243 offset:4328
    v_mov_b32 v238, v241
    v_mov_b32 v246, 0
    v_mov_b32 v60, 0
    v_mov_b32 v61, 0
    v_mov_b32 v62, 0
    v_mov_b32 v63, 0
    v_mov_b32 v213, 0
    v_mov_b32 v216, 0
    v_mov_b32 v217, 0
    v_mov_b32 v218, 0
    v_mov_b32 v219, 0
    s_waitcnt lgkmcnt(0)
    v_mul_f32 v245, s74, v244
    v_mul_f32 v212, s74, v211
    s_nop 1
    s_branch L_BG
L_FINI:
    s_mov_b64 exec, 1
    ds_add_rtn_u32 v229, v235, v234 offset:4116
    s_mov_b64 exec, -1
    v_lshlrev_b32 v40, 4, v0
    v_and_b32 v36, 0x18, v0
    v_lshlrev_b32 v36, 4, v36
    v_and_b32 v37, 3, v0
    v_lshl_add_u32 v36, v37, 5, v36
    v_and_b32 v37, 4, v0
    v_lshl_add_u32 v36, v37, 2, v36
    s_mov_b32 s76, 0x7060500
    s_mov_b32 s77, 0x7060501
    s_mov_b32 s78, 0x7060502
    s_mov_b32 s79, 0x7060503
    s_add_u32 s95, s95, 1
    s_and_b32 s95, s95, 0xff
    s_mul_i32 s94, s95, 0x01010101
    s_xor_b32 s94, s94, 0xd93ca500
    v_bfe_u32 v37, v0, 2, 1
    v_mul_u32_u24 v37, 0x202, v37
    v_add_u32 v37, 0x07060100, v37
    s_lshl3_add_u32 s64, s100, s4
    s_lshl_b32 s64, s64, 9
    s_add_u32 s64, s64, 393216
    s_waitcnt lgkmcnt(0)
    v_readfirstlane_b32 s71, v229
    s_cmp_ge_u32 s71, 12
    s_cbranch_scc1 L_FMERGE
L_SEND:
    s_endpgm
SLOW_1:
    s_nop 7
    v_mov_b32 v247, v248
    s_nop 1
    v_permlane16_swap_b32 v248, v247
    v_max_f32 v248, v248, v247
    v_mov_b32 v247, v248
    s_nop 1
    v_permlane32_swap_b32 v248, v247
    v_max3_f32 v248, v248, v247, v244
    v_sub_f32 v247, v244, v248
    v_mul_f32 v247, s75, v247
    v_exp_f32 v247, v247
    v_mov_b32 v244, v248
    v_mul_f32 v245, s74, v248
    v_mul_f32 v246, v246, v247
    v_mul_f32 v60, v60, v247
    v_mul_f32 v61, v61, v247
    v_mul_f32 v62, v62, v247
    v_mul_f32 v63, v63, v247
    s_nop 1
    s_branch BACK_2
SLOW_3:
    s_nop 7
    v_mov_b32 v247, v248
    s_nop 1
    v_permlane16_swap_b32 v248, v247
    v_max_f32 v248, v248, v247
    v_mov_b32 v247, v248
    s_nop 1
    v_permlane32_swap_b32 v248, v247
    v_max3_f32 v248, v248, v247, v244
    v_sub_f32 v247, v244, v248
    v_mul_f32 v247, s75, v247
    v_exp_f32 v247, v247
    v_mov_b32 v244, v248
    v_mul_f32 v245, s74, v248
    v_mul_f32 v246, v246, v247
    v_mul_f32 v60, v60, v247
    v_mul_f32 v61, v61, v247
    v_mul_f32 v62, v62, v247
    v_mul_f32 v63, v63, v247
    s_nop 1
    s_branch BACK_4
SLOW_5:
    s_nop 7
    v_mov_b32 v247, v248
    s_nop 1
    v_permlane16_swap_b32 v248, v247
    v_max_f32 v248, v248, v247
    v_mov_b32 v247, v248
    s_nop 1
    v_permlane32_swap_b32 v248, v247
    v_max3_f32 v248, v248, v247, v244
    v_sub_f32 v247, v244, v248
    v_mul_f32 v247, s75, v247
    v_exp_f32 v247, v247
    v_mov_b32 v244, v248
    v_mul_f32 v245, s74, v248
    v_mul_f32 v246, v246, v247
    v_mul_f32 v60, v60, v247
    v_mul_f32 v61, v61, v247
    v_mul_f32 v62, v62, v247
    v_mul_f32 v63, v63, v247
    s_nop 1
    s_branch BACK_6
SLOW_7:
    s_nop 7
    v_mov_b32 v247, v248
    s_nop 1
    v_permlane16_swap_b32 v248, v247
    v_max_f32 v248, v248, v247
    v_mov_b32 v247, v248
    s_nop 1
    v_permlane32_swap_b32 v248, v247
    v_max3_f32 v248, v248, v247, v244
    v_sub_f32 v247, v244, v248
    v_mul_f32 v247, s75, v247
    v_exp_f32 v247, v247
    v_mov_b32 v244, v248
    v_mul_f32 v245, s74, v248
    v_mul_f32 v246, v246, v247
    v_mul_f32 v60, v60, v247
    v_mul_f32 v61, v61, v247
    v_mul_f32 v62, v62, v247
    v_mul_f32 v63, v63, v247
    s_nop 1
    s_branch BACK_8
L_SPK:
    s_sleep 1
    s_mov_b64 exec, 1
    ds_read_b32 v230, v229
    s_mov_b64 exec, -1
    s_sub_u32 s70, s70, 1
    s_waitcnt lgkmcnt(0)
    s_cbranch_scc0 L_KC
    v_mov_b32 v230, 0xf0000081
    s_mov_b32 s70, 0
    s_nop 1
    s_branch L_KC
L_SPA:
    s_sleep 1
    s_mov_b64 exec, 1
    ds_read_b32 v230, v229
    s_mov_b64 exec, -1
    s_sub_u32 s70, s70, 1
    s_waitcnt lgkmcnt(0)
    s_cbranch_scc0 L_AC
    v_mov_b32 v230, 0xf0000081
    s_mov_b32 s70, 0
    s_nop 1
    s_branch L_AC
L_SPB:
    s_sleep 1
    s_mov_b64 exec, 1
    ds_read_b32 v230, v229
    s_mov_b64 exec, -1
    s_sub_u32 s70, s70, 1
    s_waitcnt lgkmcnt(0)
    s_cbranch_scc0 L_BC
    v_mov_b32 v230, 0xf0000081
    s_mov_b32 s70, 0
    s_nop 1
    s_branch L_BC
L_SPF:
    s_sleep 1
    s_mov_b64 exec, 1
    ds_read_b32 v230, v229
    s_mov_b64 exec, -1
    s_sub_u32 s70, s70, 1
    s_waitcnt lgkmcnt(0)
    s_cbranch_scc0 L_FC
    v_mov_b32 v230, 0xf0000081
    s_mov_b32 s70, 0
    s_nop 1
    s_branch L_FC
L_SPG0:
    s_sleep 1
    s_mov_b64 exec, 1
    ds_read_b32 v230, v229
    s_mov_b64 exec, -1
    s_sub_u32 s70, s70, 1
    s_waitcnt lgkmcnt(0)
    s_cbranch_scc0 L_G0C
    v_mov_b32 v230, 0xf0000081
    s_mov_b32 s70, 0
    s_nop 1
    s_branch L_G0C
L_SPG1:
    s_sleep 1
    s_mov_b64 exec, 1
    ds_read_b32 v230, v229
    s_mov_b64 exec, -1
    s_sub_u32 s70, s70, 1
    s_waitcnt lgkmcnt(0)
    s_cbranch_scc0 L_G1C
    v_mov_b32 v230, 0xf0000081
    s_mov_b32 s70, 0
    s_nop 1
    s_branch L_G1C
L_AUX:
    s_setprio 3
    s_load_dwordx2 s[8:9], s[0:1], 0
    s_load_dwordx2 s[12:13], s[0:1], 24
    s_load_dwordx2 s[24:25], s[0:1], 104
    s_load_dwordx2 s[32:33], s[0:1], 64
    s_mov_b32 s10, 0x1000
    s_mov_b32 s11, 0x20000
    s_mov_b32 s14, 0x400000
    s_mov_b32 s15, 0x20000
    s_mov_b32 s26, 0x40000000
    s_mov_b32 s27, 0x20000
    s_sub_u32 s56, s3, 4
    s_lshr_b32 s6, s20, 21
    s_bfe_u32 s7, s2, 0x30003
    v_and_b32 v1, 15, v0
    v_lshrrev_b32 v2, 4, v0
    v_lshrrev_b32 v54, 3, v1
    v_and_b32 v53, 7, v1
    v_lshlrev_b32 v60, 4, v53
    v_lshl_add_u32 v60, v54, 16, v60
    v_lshl_add_u32 v60, v2, 17, v60
    v_lshlrev_b32 v61, 10, v54
    v_lshl_add_u32 v61, v2, 5, v61
    s_bfe_u32 s62, s5, 0x20002
    s_lshl2_add_u32 s62, s4, s62
    s_and_b32 s58, s5, 1
    s_lshl2_add_u32 s58, s58, s56
    s_lshl_b32 s57, s58, 19
    s_lshl_b32 s59, s62, 8
    s_add_u32 s57, s57, s59
    s_and_b32 s63, s5, 2
    s_lshl_b32 s59, s63, 6
    s_add_u32 s57, s57, s59
    s_lshl_b32 s58, s58, 7
    s_mov_b32 s59, 3932160
    s_cmp_lt_u32 s2, 128
    s_waitcnt lgkmcnt(0)
    s_cselect_b64 s[12:13], s[12:13], s[32:33]
    s_load_dword s95, s[24:25], s59
    s_barrier
    buffer_load_dwordx4 v[12:15], v61, s[8:11], s58 offen offset:0
    buffer_load_dwordx4 v[16:19], v61, s[8:11], s58 offen offset:16
    buffer_load_dwordx4 v[20:23], v61, s[8:11], s58 offen offset:2048
    buffer_load_dwordx4 v[24:27], v61, s[8:11], s58 offen offset:2064
    buffer_load_dwordx4 v[64:67], v60, s[12:15], s57 offen nt
    s_add_u32 s57, s57, 0x2000
    buffer_load_dwordx4 v[68:71], v60, s[12:15], s57 offen nt
    s_add_u32 s57, s57, 0x2000
    buffer_load_dwordx4 v[72:75], v60, s[12:15], s57 offen nt
    s_add_u32 s57, s57, 0x2000
    buffer_load_dwordx4 v[76:79], v60, s[12:15], s57 offen nt
    s_add_u32 s57, s57, 0x2000
    buffer_load_dwordx4 v[80:83], v60, s[12:15], s57 offen nt
    s_add_u32 s57, s57, 0x2000
    buffer_load_dwordx4 v[84:87], v60, s[12:15], s57 offen nt
    s_add_u32 s57, s57, 0x2000
    buffer_load_dwordx4 v[88:91], v60, s[12:15], s57 offen nt
    s_add_u32 s57, s57, 0x2000
    buffer_load_dwordx4 v[92:95], v60, s[12:15], s57 offen nt
    s_mov_b32 s75, 0x3fb8aa3b
    v_and_b32 v44, 1, v0
    v_cmp_eq_u32 vcc, 1, v44
    v_mov_b32 v45, 0x0c0c0100
    v_mov_b32 v46, 0x01000c0c
    v_cndmask_b32 v45, v45, v46, vcc
    v_mov_b32 v46, 0x0c0c0302
    v_mov_b32 v47, 0x03020c0c
    v_cndmask_b32 v46, v46, v47, vcc
    v_bfe_u32 v44, v0, 1, 2
    v_mov_b32 v47, 0x0c0c0c0c
    v_cmp_eq_u32 vcc, 0, v44
    s_nop 1
    v_cndmask_b32 v4, v47, v45, vcc
    v_cndmask_b32 v8, v47, v46, vcc
    v_cmp_eq_u32 vcc, 1, v44
    s_nop 1
    v_cndmask_b32 v5, v47, v45, vcc
    v_cndmask_b32 v9, v47, v46, vcc
    v_cmp_eq_u32 vcc, 2, v44
    s_nop 1
    v_cndmask_b32 v6, v47, v45, vcc
    v_cndmask_b32 v10, v47, v46, vcc
    v_cmp_eq_u32 vcc, 3, v44
    s_nop 1
    v_cndmask_b32 v7, v47, v45, vcc
    v_cndmask_b32 v11, v47, v46, vcc
    s_and_b32 s59, s4, 6
    s_add_u32 s59, s59, s5
    s_and_b32 s59, s59, 31
    v_mov_b32 v60, 1
    v_mov_b32 v61, 0
    v_mov_b32 v44, 0
    v_mov_b32 v45, 0
    v_mov_b32 v46, 0
    v_mov_b32 v47, 0
    v_lshlrev_b32 v48, 4, v0
    s_cmp_eq_u32 s56, 2
    s_cbranch_scc1 L_NEUT
    s_cmp_lg_u32 s56, 3
    s_cbranch_scc1 L_NORQ
    v_lshrrev_b32 v49, 5, v0
    v_and_b32 v50, 31, v0
    v_lshlrev_b32 v51, 2, v0
    v_and_b32 v44, 3, v50
    v_lshlrev_b32 v44, 12, v44
    v_bfe_i32 v45, v50, 2, 1
    v_and_b32 v45, 0x8100, v45
    v_xor_b32 v44, v44, v45
    v_bfe_i32 v45, v50, 3, 1
    v_and_b32 v45, 0x80200, v45
    v_xor_b32 v44, v44, v45
    v_bfe_i32 v45, v50, 4, 1
    v_and_b32 v45, 0x100800, v45
    v_xor_b32 v44, v44, v45
    v_xor_b32 v44, s20, v44
    v_lshl_add_u32 v45, v49, 26, v44
    v_lshl_add_u32 v45, v49, 4, v45
    v_or_b32 v45, 1029, v45
    s_mov_b32 exec_hi, 0
    ds_write_b32 v51, v45 offset:0
    s_mov_b32 exec_hi, -1
    v_xor_b32 v45, 12, v45
    s_mov_b32 exec_hi, 0
    ds_write_b32 v51, v45 offset:528
    s_mov_b64 exec, -1
    s_mov_b32 exec_lo, 0
    ds_write_b32 v51, v45 offset:528
    s_mov_b64 exec, -1
    s_lshl_b32 s60, s100, 21
    s_mul_i32 s61, s4, 163840
    s_add_u32 s60, s60, s61
    s_add_u32 s60, s60, 67108880
    v_and_b32 v46, 3, v50
    v_lshlrev_b32 v46, 12, v46
    v_bfe_i32 v47, v50, 2, 1
    v_and_b32 v47, 0x8100, v47
    v_xor_b32 v46, v46, v47
    v_bfe_i32 v47, v50, 3, 1
    v_and_b32 v47, 0x10200, v47
    v_xor_b32 v46, v46, v47
    v_bfe_i32 v47, v50, 4, 1
    v_and_b32 v47, 0x20800, v47
    v_xor_b32 v46, v46, v47
    v_add_u32 v46, s60, v46
    v_cmp_eq_u32 vcc, 1, v49
    s_nop 1
    v_cndmask_b32 v46, v44, v46, vcc
    v_add_u32 v46, 134218793, v46
    s_lshl_b32 s60, s59, 21
    s_lshl_b32 s61, s4, 16
    s_add_u32 s60, s60, s61
    s_add_u32 s60, s60, 1573961
    s_and_b32 s61, s59, 2
    s_lshl_b32 s61, s61, 13
    s_add_u32 s60, s60, s61
    v_and_b32 v47, 3, v50
    v_lshlrev_b32 v47, 12, v47
    v_bfe_i32 v52, v50, 2, 1
    v_and_b32 v52, 0x8100, v52
    v_xor_b32 v47, v47, v52
    v_bfe_i32 v52, v50, 3, 1
    v_and_b32 v52, 0x10200, v52
    v_xor_b32 v47, v47, v52
    v_bfe_i32 v52, v50, 4, 1
    v_and_b32 v52, 0x20800, v52
    v_xor_b32 v47, v47, v52
    v_add_u32 v47, s60, v47
    v_mov_b32 v52, 0xff61b1e6
    s_mov_b32 exec_hi, 0
    ds_write_b32 v51, v46 offset:784
    ds_write_b32 v51, v52 offset:4256
    s_mov_b32 exec_lo, 0xff
    ds_write_b32 v51, v47 offset:496
    s_mov_b32 exec_hi, 0xfffff
    s_mov_b32 exec_lo, 0
    ds_write_b32 v51, v46 offset:784
    s_mov_b64 exec, -1
    v_mov_b32 v49, 80
    s_mov_b64 exec, 1
    v_mov_b32 v50, -1
    ds_write_b32 v48, v49 offset:4128
    ds_write_b32 v48, v50 offset:4132
    s_mov_b64 exec, -1
    s_branch L_INITD
L_NEUT:
    ds_write_b128 v48, v[44:47] offset:15360
    ds_write_b128 v48, v[44:47] offset:16384
    ds_write_b128 v48, v[44:47] offset:17408
    ds_write_b128 v48, v[44:47] offset:18432
    ds_write_b128 v48, v[44:47] offset:19456
    ds_write_b128 v48, v[44:47] offset:20480
    ds_write_b128 v48, v[44:47] offset:21504
    ds_write_b128 v48, v[44:47] offset:22528
    ds_write_b128 v48, v[44:47] offset:23552
    ds_write_b128 v48, v[44:47] offset:24576
    ds_write_b128 v48, v[44:47] offset:25600
    ds_write_b128 v48, v[44:47] offset:26624
    ds_write_b128 v48, v[44:47] offset:27648
    ds_write_b128 v48, v[44:47] offset:28672
    ds_write_b128 v48, v[44:47] offset:29696
    ds_write_b128 v48, v[44:47] offset:30720
    ds_write_b128 v48, v[44:47] offset:31744
    v_bfe_u32 v49, v0, 2, 3
    v_mul_u32_u24 v49, 2176, v49
    v_and_b32 v50, 3, v0
    v_lshl_add_u32 v49, v50, 2, v49
    v_mov_b32 v44, 0xff61b1e6
    ds_write_b32 v49, v44 offset:17408
L_INITD:
    ds_add_u32 v61, v60 offset:4168
L_NORQ:
    v_and_b32 v62, 1, v2
    v_lshlrev_b32 v62, 4, v62
    v_lshl_add_u32 v62, v1, 5, v62
    v_lshrrev_b32 v63, 5, v0
    v_lshl_add_u32 v62, v63, 9, v62
    s_lshl_b32 s60, s56, 11
    v_add_u32 v63, s60, v62
    v_lshlrev_b32 v40, 4, v0
    v_lshlrev_b32 v28, 10, v54
    v_lshl_add_u32 v28, v53, 5, v28
    v_lshrrev_b32 v29, 1, v2
    v_lshl_add_u32 v28, v29, 8, v28
    v_and_b32 v29, 1, v2
    v_lshl_add_u32 v28, v29, 4, v28
    v_add_u32 v28, s60, v28
    v_lshlrev_b32 v29, 15, v2
    v_lshl_add_u32 v29, v1, 4, v29
    v_and_b32 v30, 31, v0
    v_lshlrev_b32 v30, 3, v30
    v_lshrrev_b32 v31, 5, v0
    v_lshl_add_u32 v30, v31, 2, v30
    v_mov_b32 v31, 0xffffff00
    s_lshr_b32 s60, s2, 7
    s_lshl_b32 s60, s60, 17
    s_lshl_b32 s61, s62, 10
    s_add_u32 s60, s60, s61
    s_and_b32 s61, s5, 1
    s_lshl_b32 s61, s61, 9
    s_add_u32 s60, s60, s61
    s_lshl_b32 s61, s63, 7
    s_add_u32 s60, s60, s61
    s_add_u32 s60, s60, 2621440
    v_cmp_eq_u32 vcc, 1, v54
    s_waitcnt vmcnt(8) lgkmcnt(0)
    s_add_u32 s95, s95, 1
    s_and_b32 s95, s95, 0xff
    s_mul_i32 s94, s95, 0x01010101
    s_xor_b32 s94, s94, 0xd93ca500
    v_bfe_u32 v37, v0, 2, 1
    v_mul_u32_u24 v37, 0x202, v37
    v_add_u32 v37, 0x07060100, v37
    v_mov_b32 v38, s94
    s_mov_b32 s76, 0x7060500
    s_mov_b32 s77, 0x7060501
    s_mov_b32 s78, 0x7060502
    s_mov_b32 s79, 0x7060503
    s_mov_b32 s66, 0x0c0c0400
    v_perm_b32 v96, v12, v12, v4
    v_perm_b32 v97, v12, v12, v5
    v_perm_b32 v98, v12, v12, v6
    v_perm_b32 v99, v12, v12, v7
    v_perm_b32 v100, v16, v16, v4
    v_perm_b32 v101, v16, v16, v5
    v_perm_b32 v102, v16, v16, v6
    v_perm_b32 v103, v16, v16, v7
    v_perm_b32 v104, v20, v20, v4
    v_perm_b32 v105, v20, v20, v5
    v_perm_b32 v106, v20, v20, v6
    v_perm_b32 v107, v20, v20, v7
    v_perm_b32 v108, v24, v24, v4
    v_perm_b32 v109, v24, v24, v5
    v_perm_b32 v110, v24, v24, v6
    v_perm_b32 v111, v24, v24, v7
    v_perm_b32 v112, v12, v12, v8
    v_perm_b32 v113, v12, v12, v9
    v_perm_b32 v114, v12, v12, v10
    v_perm_b32 v115, v12, v12, v11
    v_perm_b32 v116, v16, v16, v8
    v_perm_b32 v117, v16, v16, v9
    v_perm_b32 v118, v16, v16, v10
    v_perm_b32 v119, v16, v16, v11
    v_perm_b32 v120, v20, v20, v8
    v_perm_b32 v121, v20, v20, v9
    v_perm_b32 v122, v20, v20, v10
    v_perm_b32 v123, v20, v20, v11
    v_perm_b32 v124, v24, v24, v8
    v_perm_b32 v125, v24, v24, v9
    v_perm_b32 v126, v24, v24, v10
    v_perm_b32 v127, v24, v24, v11
    s_waitcnt vmcnt(7)
    v_mfma_f32_16x16x32_bf16 v[224:227], v[96:99], v[64:67], 0
    v_mfma_f32_16x16x32_bf16 v[228:231], v[100:103], v[64:67], 0
    v_mfma_f32_16x16x32_bf16 v[232:235], v[104:107], v[64:67], 0
    v_mfma_f32_16x16x32_bf16 v[236:239], v[108:111], v[64:67], 0
    v_perm_b32 v128, v13, v13, v4
    v_perm_b32 v129, v13, v13, v5
    v_perm_b32 v130, v13, v13, v6
    v_perm_b32 v131, v13, v13, v7
    v_perm_b32 v132, v17, v17, v4
    v_perm_b32 v133, v17, v17, v5
    v_perm_b32 v134, v17, v17, v6
    v_perm_b32 v135, v17, v17, v7
    v_perm_b32 v136, v21, v21, v4
    v_perm_b32 v137, v21, v21, v5
    v_perm_b32 v138, v21, v21, v6
    v_perm_b32 v139, v21, v21, v7
    v_perm_b32 v140, v25, v25, v4
    v_perm_b32 v141, v25, v25, v5
    v_perm_b32 v142, v25, v25, v6
    v_perm_b32 v143, v25, v25, v7
    s_waitcnt vmcnt(6)
    v_mfma_f32_16x16x32_bf16 v[224:227], v[112:115], v[68:71], v[224:227]
    v_mfma_f32_16x16x32_bf16 v[228:231], v[116:119], v[68:71], v[228:231]
    v_mfma_f32_16x16x32_bf16 v[232:235], v[120:123], v[68:71], v[232:235]
    v_mfma_f32_16x16x32_bf16 v[236:239], v[124:127], v[68:71], v[236:239]
    v_perm_b32 v144, v13, v13, v8
    v_perm_b32 v145, v13, v13, v9
    v_perm_b32 v146, v13, v13, v10
    v_perm_b32 v147, v13, v13, v11
    v_perm_b32 v148, v17, v17, v8
    v_perm_b32 v149, v17, v17, v9
    v_perm_b32 v150, v17, v17, v10
    v_perm_b32 v151, v17, v17, v11
    v_perm_b32 v152, v21, v21, v8
    v_perm_b32 v153, v21, v21, v9
    v_perm_b32 v154, v21, v21, v10
    v_perm_b32 v155, v21, v21, v11
    v_perm_b32 v156, v25, v25, v8
    v_perm_b32 v157, v25, v25, v9
    v_perm_b32 v158, v25, v25, v10
    v_perm_b32 v159, v25, v25, v11
    s_waitcnt vmcnt(5)
    v_mfma_f32_16x16x32_bf16 v[224:227], v[128:131], v[72:75], v[224:227]
    v_mfma_f32_16x16x32_bf16 v[228:231], v[132:135], v[72:75], v[228:231]
    v_mfma_f32_16x16x32_bf16 v[232:235], v[136:139], v[72:75], v[232:235]
    v_mfma_f32_16x16x32_bf16 v[236:239], v[140:143], v[72:75], v[236:239]
    v_perm_b32 v160, v14, v14, v4
    v_perm_b32 v161, v14, v14, v5
    v_perm_b32 v162, v14, v14, v6
    v_perm_b32 v163, v14, v14, v7
    v_perm_b32 v164, v18, v18, v4
    v_perm_b32 v165, v18, v18, v5
    v_perm_b32 v166, v18, v18, v6
    v_perm_b32 v167, v18, v18, v7
    v_perm_b32 v168, v22, v22, v4
    v_perm_b32 v169, v22, v22, v5
    v_perm_b32 v170, v22, v22, v6
    v_perm_b32 v171, v22, v22, v7
    v_perm_b32 v172, v26, v26, v4
    v_perm_b32 v173, v26, v26, v5
    v_perm_b32 v174, v26, v26, v6
    v_perm_b32 v175, v26, v26, v7
    s_waitcnt vmcnt(4)
    v_mfma_f32_16x16x32_bf16 v[224:227], v[144:147], v[76:79], v[224:227]
    v_mfma_f32_16x16x32_bf16 v[228:231], v[148:151], v[76:79], v[228:231]
    v_mfma_f32_16x16x32_bf16 v[232:235], v[152:155], v[76:79], v[232:235]
    v_mfma_f32_16x16x32_bf16 v[236:239], v[156:159], v[76:79], v[236:239]
    v_perm_b32 v176, v14, v14, v8
    v_perm_b32 v177, v14, v14, v9
    v_perm_b32 v178, v14, v14, v10
    v_perm_b32 v179, v14, v14, v11
    v_perm_b32 v180, v18, v18, v8
    v_perm_b32 v181, v18, v18, v9
    v_perm_b32 v182, v18, v18, v10
    v_perm_b32 v183, v18, v18, v11
    v_perm_b32 v184, v22, v22, v8
    v_perm_b32 v185, v22, v22, v9
    v_perm_b32 v186, v22, v22, v10
    v_perm_b32 v187, v22, v22, v11
    v_perm_b32 v188, v26, v26, v8
    v_perm_b32 v189, v26, v26, v9
    v_perm_b32 v190, v26, v26, v10
    v_perm_b32 v191, v26, v26, v11
    s_waitcnt vmcnt(3)
    v_mfma_f32_16x16x32_bf16 v[224:227], v[160:163], v[80:83], v[224:227]
    v_mfma_f32_16x16x32_bf16 v[228:231], v[164:167], v[80:83], v[228:231]
    v_mfma_f32_16x16x32_bf16 v[232:235], v[168:171], v[80:83], v[232:235]
    v_mfma_f32_16x16x32_bf16 v[236:239], v[172:175], v[80:83], v[236:239]
    v_perm_b32 v192, v15, v15, v4
    v_perm_b32 v193, v15, v15, v5
    v_perm_b32 v194, v15, v15, v6
    v_perm_b32 v195, v15, v15, v7
    v_perm_b32 v196, v19, v19, v4
    v_perm_b32 v197, v19, v19, v5
    v_perm_b32 v198, v19, v19, v6
    v_perm_b32 v199, v19, v19, v7
    v_perm_b32 v200, v23, v23, v4
    v_perm_b32 v201, v23, v23, v5
    v_perm_b32 v202, v23, v23, v6
    v_perm_b32 v203, v23, v23, v7
    v_perm_b32 v204, v27, v27, v4
    v_perm_b32 v205, v27, v27, v5
    v_perm_b32 v206, v27, v27, v6
    v_perm_b32 v207, v27, v27, v7
    s_waitcnt vmcnt(2)
    v_mfma_f32_16x16x32_bf16 v[224:227], v[176:179], v[84:87], v[224:227]
    v_mfma_f32_16x16x32_bf16 v[228:231], v[180:183], v[84:87], v[228:231]
    v_mfma_f32_16x16x32_bf16 v[232:235], v[184:187], v[84:87], v[232:235]
    v_mfma_f32_16x16x32_bf16 v[236:239], v[188:191], v[84:87], v[236:239]
    v_perm_b32 v208, v15, v15, v8
    v_perm_b32 v209, v15, v15, v9
    v_perm_b32 v210, v15, v15, v10
    v_perm_b32 v211, v15, v15, v11
    v_perm_b32 v212, v19, v19, v8
    v_perm_b32 v213, v19, v19, v9
    v_perm_b32 v214, v19, v19, v10
    v_perm_b32 v215, v19, v19, v11
    v_perm_b32 v216, v23, v23, v8
    v_perm_b32 v217, v23, v23, v9
    v_perm_b32 v218, v23, v23, v10
    v_perm_b32 v219, v23, v23, v11
    v_perm_b32 v220, v27, v27, v8
    v_perm_b32 v221, v27, v27, v9
    v_perm_b32 v222, v27, v27, v10
    v_perm_b32 v223, v27, v27, v11
    s_waitcnt vmcnt(1)
    v_mfma_f32_16x16x32_bf16 v[224:227], v[192:195], v[88:91], v[224:227]
    v_mfma_f32_16x16x32_bf16 v[228:231], v[196:199], v[88:91], v[228:231]
    v_mfma_f32_16x16x32_bf16 v[232:235], v[200:203], v[88:91], v[232:235]
    v_mfma_f32_16x16x32_bf16 v[236:239], v[204:207], v[88:91], v[236:239]
    s_waitcnt vmcnt(0)
    v_mfma_f32_16x16x32_bf16 v[224:227], v[208:211], v[92:95], v[224:227]
    v_mfma_f32_16x16x32_bf16 v[228:231], v[212:215], v[92:95], v[228:231]
    v_mfma_f32_16x16x32_bf16 v[232:235], v[216:219], v[92:95], v[232:235]
    v_mfma_f32_16x16x32_bf16 v[236:239], v[220:223], v[92:95], v[236:239]
    s_nop 5
    v_cndmask_b32 v44, v224, v228, vcc
    v_cndmask_b32 v45, v225, v229, vcc
    v_cndmask_b32 v46, v226, v230, vcc
    v_cndmask_b32 v47, v227, v231, vcc
    ds_write_b128 v28, v[44:47] offset:32768
    v_cndmask_b32 v48, v232, v236, vcc
    v_cndmask_b32 v49, v233, v237, vcc
    v_cndmask_b32 v50, v234, v238, vcc
    v_cndmask_b32 v51, v235, v239, vcc
    ds_write_b128 v28, v[48:51] offset:33280
    s_mov_b64 exec, 1
    ds_add_rtn_u32 v59, v61, v60 offset:4160
    s_mov_b64 exec, -1
    s_waitcnt lgkmcnt(0)
    v_readfirstlane_b32 s71, v59
    s_cmp_lg_u32 s71, 3
    s_cbranch_scc1 L_NOS1
    ds_read_b128 v[192:195], v40 offset:32768
    ds_read_b128 v[196:199], v40 offset:33792
    ds_read_b128 v[200:203], v40 offset:34816
    ds_read_b128 v[204:207], v40 offset:35840
    ds_read_b128 v[208:211], v40 offset:36864
    ds_read_b128 v[212:215], v40 offset:37888
    ds_read_b128 v[216:219], v40 offset:38912
    ds_read_b128 v[220:223], v40 offset:39936
    s_waitcnt lgkmcnt(6)
    v_add_f32 v192, v192, v196
    v_add_f32 v193, v193, v197
    v_add_f32 v194, v194, v198
    v_add_f32 v195, v195, v199
    s_waitcnt lgkmcnt(4)
    v_add_f32 v200, v200, v204
    v_add_f32 v201, v201, v205
    v_add_f32 v202, v202, v206
    v_add_f32 v203, v203, v207
    v_add_f32 v192, v192, v200
    v_add_f32 v193, v193, v201
    v_add_f32 v194, v194, v202
    v_add_f32 v195, v195, v203
    s_waitcnt lgkmcnt(2)
    v_add_f32 v208, v208, v212
    v_add_f32 v209, v209, v213
    v_add_f32 v210, v210, v214
    v_add_f32 v211, v211, v215
    s_waitcnt lgkmcnt(0)
    v_add_f32 v216, v216, v220
    v_add_f32 v217, v217, v221
    v_add_f32 v218, v218, v222
    v_add_f32 v219, v219, v223
    v_add_f32 v208, v208, v216
    v_add_f32 v209, v209, v217
    v_add_f32 v210, v210, v218
    v_add_f32 v211, v211, v219
    v_add_f32 v192, v192, v208
    v_add_f32 v193, v193, v209
    v_add_f32 v194, v194, v210
    v_add_f32 v195, v195, v211
    v_perm_b32 v192, v192, v38, s76
    v_perm_b32 v193, v193, v38, s77
    v_perm_b32 v194, v194, v38, s78
    v_perm_b32 v195, v195, v38, s79
    buffer_store_dwordx4 v[192:195], v29, s[24:27], s60 offen sc1
L_NOS1:
    s_cmp_eq_u32 s56, 3
    s_cbranch_scc1 L_NOQ
    s_lshl_b32 s60, s56, 15
    s_lshl_b32 s61, s6, 10
    s_add_u32 s60, s60, s61
    s_add_u32 s60, s60, 2621440
    s_lshl_b32 s61, s56, 8
    v_add_u32 v32, s61, v30
    s_cmp_eq_u32 s56, 0
    s_cbranch_scc1 L_Q0
    s_mov_b32 s70, 1600000
LW_9:
    ds_read_b32 v59, v61 offset:4168
    s_waitcnt lgkmcnt(0)
    v_readfirstlane_b32 s71, v59
    s_cmp_ge_u32 s71, 192
    s_cbranch_scc1 LWD_10
    s_sleep 4
    s_sub_u32 s70, s70, 1
    s_cmp_lg_u32 s70, 0
    s_cbranch_scc1 LW_9
LWD_10:
    s_branch L_Q1
L_Q0:
    s_mov_b32 s70, 1600000
LW_11:
    ds_read_b32 v59, v61 offset:4172
    s_waitcnt lgkmcnt(0)
    v_readfirstlane_b32 s71, v59
    s_cmp_ge_u32 s71, 256
    s_cbranch_scc1 LWD_12
    s_sleep 2
    s_sub_u32 s70, s70, 1
    s_cmp_lg_u32 s70, 0
    s_cbranch_scc1 LW_11
LWD_12:
L_Q1:
    s_mov_b32 s70, 100000
    s_branch L_QPXA
L_QPA:
    s_sleep 8
L_QPXA:
    buffer_load_dwordx4 v[44:47], v40, s[24:27], s60 offen sc1
    s_waitcnt vmcnt(0)
    v_perm_b32 v56, v45, v44, s66
    v_perm_b32 v57, v47, v46, s66
    v_lshl_or_b32 v56, v57, 16, v56
    v_xor_b32 v58, s94, v56
    v_cmp_ne_u32 vcc, 0, v58
    s_cbranch_vccz L_QPDA
    s_sub_u32 s70, s70, 1
    s_cmp_lg_u32 s70, 0
    s_cbranch_scc1 L_QPA
L_QPDA:
    v_and_b32 v44, v31, v44
    v_and_b32 v45, v31, v45
    v_and_b32 v46, v31, v46
    v_and_b32 v47, v31, v47
    s_nop 0
    v_permlane32_swap_b32 v44, v46
    v_permlane32_swap_b32 v45, v47
    v_add_f32 v44, v44, v46
    v_add_f32 v45, v45, v47
    v_cvt_pk_bf16_f32 v44, v44, v45
    ds_write_b32 v32, v44 offset:13312
    s_cmp_eq_u32 s56, 0
    s_cbranch_scc0 L_QK
    ds_add_u32 v61, v60 offset:4168
    s_branch L_NOQ
L_QK:
    s_mul_i32 s60, s56, 67108880
    s_add_u32 s60, s60, s20
    s_add_u32 s60, s60, 1029
    v_and_b32 v44, 3, v0
    v_lshlrev_b32 v44, 12, v44
    v_bfe_i32 v45, v0, 2, 1
    v_and_b32 v45, 0x8100, v45
    v_xor_b32 v44, v44, v45
    v_bfe_i32 v45, v0, 3, 1
    v_and_b32 v45, 0x80200, v45
    v_xor_b32 v44, v44, v45
    v_bfe_i32 v45, v0, 4, 1
    v_and_b32 v45, 0x100800, v45
    v_xor_b32 v44, v44, v45
    v_xor_b32 v44, s60, v44
    v_lshlrev_b32 v45, 2, v0
    s_lshl_b32 s61, s56, 7
    v_add_u32 v45, s61, v45
    s_mov_b32 exec_hi, 0
    ds_write_b32 v45, v44 offset:0
    s_mov_b32 exec_hi, -1
L_NOQ:
    v_and_b32 v36, 0x18, v0
    v_lshlrev_b32 v36, 4, v36
    v_and_b32 v47, 3, v0
    v_lshl_add_u32 v36, v47, 5, v36
    v_and_b32 v47, 4, v0
    v_lshl_add_u32 v36, v47, 2, v36
    s_load_dwordx2 s[86:87], s[0:1], 32
    s_load_dwordx2 s[88:89], s[0:1], 72
    s_load_dwordx2 s[16:17], s[0:1], 80
    s_load_dwordx2 s[36:37], s[0:1], 88
    s_mov_b32 s18, 0x400
    s_mov_b32 s19, 0x20000
    s_mov_b32 s38, 0x1000
    s_mov_b32 s39, 0x20000
    s_and_b32 s84, s5, 3
    s_lshr_b32 s85, s2, 5
    s_lshl_b32 s85, s85, 3
    s_add_u32 s85, s85, s4
    v_lshlrev_b32 v80, 4, v1
    v_lshl_add_u32 v80, v2, 13, v80
    v_lshrrev_b32 v81, 3, v1
    v_lshlrev_b32 v81, 17, v81
    v_and_b32 v82, 7, v1
    v_lshl_add_u32 v81, v82, 9, v81
    v_lshl_add_u32 v81, v2, 4, v81
    v_mov_b32 v82, v63
    v_lshrrev_b32 v83, 5, v0
    v_lshlrev_b32 v83, 17, v83
    v_bfe_u32 v84, v0, 3, 2
    v_lshl_add_u32 v83, v84, 13, v83
    v_and_b32 v84, 7, v0
    v_lshl_add_u32 v83, v84, 4, v83
    s_cmp_lt_u32 s2, 128
    s_waitcnt lgkmcnt(0)
    s_cselect_b64 s[12:13], s[86:87], s[88:89]
    s_and_b32 s60, s85, 31
    s_lshl_b32 s86, s60, 17
    s_lshl_b32 s61, s56, 15
    s_add_u32 s86, s86, s61
    s_lshl_b32 s61, s84, 8
    s_add_u32 s86, s86, s61
    s_add_u32 s87, s86, 0x1000
    s_lshr_b32 s61, s85, 5
    s_lshl_b32 s88, s61, 19
    s_lshl_b32 s61, s60, 12
    s_add_u32 s88, s88, s61
    s_lshl_b32 s61, s56, 7
    s_add_u32 s88, s88, s61
    s_add_u32 s89, s88, 0x40000
    s_lshl_b32 s92, s84, 15
    s_lshl_b32 s61, s85, 7
    s_add_u32 s92, s92, s61
    s_add_u32 s92, s92, 1048576
    s_add_u32 s93, s92, 0x40000
    s_lshl_b32 s90, s60, 1
    s_add_u32 s90, s90, s84
    s_and_b32 s61, s2, 0x90
    s_lshl_b32 s91, s56, 8
    s_or_b32 s61, s61, s91
    s_cmp_eq_u32 s61, 0x380
    s_cselect_b32 s91, 1, 0
    s_cmp_eq_u32 s56, 1
    s_cbranch_scc1 L_S1
    s_cmp_eq_u32 s56, 2
    s_cbranch_scc1 L_QF
    s_cmp_eq_u32 s56, 3
    s_cbranch_scc1 L_DISP
    s_lshl_b32 s64, s6, 3
    s_add_u32 s64, s64, s7
    s_lshl_b32 s64, s64, 9
    s_mov_b32 s70, 1600000
LW_13:
    ds_read_b32 v59, v61 offset:4096
    s_waitcnt lgkmcnt(0)
    v_readfirstlane_b32 s71, v59
    s_cmp_ge_u32 s71, 2048
    s_cbranch_scc1 LWD_14
    s_sleep 16
    s_sub_u32 s70, s70, 1
    s_cmp_lg_u32 s70, 0
    s_cbranch_scc1 LW_13
LWD_14:
    ds_read_b128 v[32:35], v61 offset:17408
    ds_read_b128 v[12:15], v61 offset:17424
    ds_read_b128 v[16:19], v61 offset:17440
    ds_read_b128 v[20:23], v61 offset:17456
    ds_read_b128 v[24:27], v61 offset:17472
    ds_read_b128 v[44:47], v36 offset:15360
    ds_read_b128 v[48:51], v36 offset:15872
    ds_read_b128 v[52:55], v36 offset:16384
    ds_read_b128 v[56:59], v36 offset:16896
    s_waitcnt lgkmcnt(8)
    v_max3_f32 v28, v32, v33, v34
    v_max_f32 v28, v28, v35
    v_sub_f32 v32, v32, v28
    v_sub_f32 v33, v33, v28
    v_sub_f32 v34, v34, v28
    v_sub_f32 v35, v35, v28
    v_mul_f32 v32, s75, v32
    v_mul_f32 v33, s75, v33
    v_mul_f32 v34, s75, v34
    v_mul_f32 v35, s75, v35
    v_exp_f32 v32, v32
    v_exp_f32 v33, v33
    v_exp_f32 v34, v34
    v_exp_f32 v35, v35
    s_waitcnt lgkmcnt(4)
    v_add_f32 v12, v12, v13
    v_add_f32 v14, v14, v15
    v_add_f32 v12, v12, v14
    v_add_f32 v16, v16, v17
    v_add_f32 v18, v18, v19
    v_add_f32 v16, v16, v18
    v_add_f32 v20, v20, v21
    v_add_f32 v22, v22, v23
    v_add_f32 v20, v20, v22
    v_add_f32 v24, v24, v25
    v_add_f32 v26, v26, v27
    v_add_f32 v24, v24, v26
    v_mul_f32 v29, v12, v32
    v_fmac_f32 v29, v16, v33
    v_fmac_f32 v29, v20, v34
    v_fmac_f32 v29, v24, v35
    v_rcp_f32 v30, v29
    v_log_f32 v31, v29
    s_waitcnt lgkmcnt(0)
    v_mul_f32 v12, v44, v32
    v_mul_f32 v13, v45, v32
    v_mul_f32 v14, v46, v32
    v_mul_f32 v15, v47, v32
    v_fmac_f32 v12, v48, v33
    v_fmac_f32 v13, v49, v33
    v_fmac_f32 v14, v50, v33
    v_fmac_f32 v15, v51, v33
    v_fmac_f32 v12, v52, v34
    v_fmac_f32 v13, v53, v34
    v_fmac_f32 v14, v54, v34
    v_fmac_f32 v15, v55, v34
    v_fmac_f32 v12, v56, v35
    v_fmac_f32 v13, v57, v35
    v_fmac_f32 v14, v58, v35
    v_fmac_f32 v15, v59, v35
    v_fmac_f32 v31, s75, v28
    v_mul_f32 v12, v12, v30
    v_mul_f32 v13, v13, v30
    v_mul_f32 v14, v14, v30
    v_mul_f32 v15, v15, v30
    v_perm_b32 v31, s94, v31, v37
    v_perm_b32 v64, v12, v31, s76
    v_perm_b32 v65, v13, v31, s77
    v_perm_b32 v66, v14, v31, s78
    v_perm_b32 v67, v15, v31, s79
    s_mov_b32 s80, s64
    s_add_u32 s64, s64, 0x20000
    s_mov_b32 s70, 1600000
LW_15:
    ds_read_b32 v59, v61 offset:4100
    s_waitcnt lgkmcnt(0)
    v_readfirstlane_b32 s71, v59
    s_cmp_ge_u32 s71, 2048
    s_cbranch_scc1 LWD_16
    s_sleep 16
    s_sub_u32 s70, s70, 1
    s_cmp_lg_u32 s70, 0
    s_cbranch_scc1 LW_15
LWD_16:
    ds_read_b128 v[32:35], v61 offset:19584
    ds_read_b128 v[12:15], v61 offset:19600
    ds_read_b128 v[16:19], v61 offset:19616
    ds_read_b128 v[20:23], v61 offset:19632
    ds_read_b128 v[24:27], v61 offset:19648
    ds_read_b128 v[44:47], v36 offset:17536
    ds_read_b128 v[48:51], v36 offset:18048
    ds_read_b128 v[52:55], v36 offset:18560
    ds_read_b128 v[56:59], v36 offset:19072
    s_waitcnt lgkmcnt(8)
    v_max3_f32 v28, v32, v33, v34
    v_max_f32 v28, v28, v35
    v_sub_f32 v32, v32, v28
    v_sub_f32 v33, v33, v28
    v_sub_f32 v34, v34, v28
    v_sub_f32 v35, v35, v28
    v_mul_f32 v32, s75, v32
    v_mul_f32 v33, s75, v33
    v_mul_f32 v34, s75, v34
    v_mul_f32 v35, s75, v35
    v_exp_f32 v32, v32
    v_exp_f32 v33, v33
    v_exp_f32 v34, v34
    v_exp_f32 v35, v35
    s_waitcnt lgkmcnt(4)
    v_add_f32 v12, v12, v13
    v_add_f32 v14, v14, v15
    v_add_f32 v12, v12, v14
    v_add_f32 v16, v16, v17
    v_add_f32 v18, v18, v19
    v_add_f32 v16, v16, v18
    v_add_f32 v20, v20, v21
    v_add_f32 v22, v22, v23
    v_add_f32 v20, v20, v22
    v_add_f32 v24, v24, v25
    v_add_f32 v26, v26, v27
    v_add_f32 v24, v24, v26
    v_mul_f32 v29, v12, v32
    v_fmac_f32 v29, v16, v33
    v_fmac_f32 v29, v20, v34
    v_fmac_f32 v29, v24, v35
    v_rcp_f32 v30, v29
    v_log_f32 v31, v29
    s_waitcnt lgkmcnt(0)
    v_mul_f32 v12, v44, v32
    v_mul_f32 v13, v45, v32
    v_mul_f32 v14, v46, v32
    v_mul_f32 v15, v47, v32
    v_fmac_f32 v12, v48, v33
    v_fmac_f32 v13, v49, v33
    v_fmac_f32 v14, v50, v33
    v_fmac_f32 v15, v51, v33
    v_fmac_f32 v12, v52, v34
    v_fmac_f32 v13, v53, v34
    v_fmac_f32 v14, v54, v34
    v_fmac_f32 v15, v55, v34
    v_fmac_f32 v12, v56, v35
    v_fmac_f32 v13, v57, v35
    v_fmac_f32 v14, v58, v35
    v_fmac_f32 v15, v59, v35
    v_fmac_f32 v31, s75, v28
    v_mul_f32 v12, v12, v30
    v_mul_f32 v13, v13, v30
    v_mul_f32 v14, v14, v30
    v_mul_f32 v15, v15, v30
    v_perm_b32 v31, s94, v31, v37
    v_perm_b32 v68, v12, v31, s76
    v_perm_b32 v69, v13, v31, s77
    v_perm_b32 v70, v14, v31, s78
    v_perm_b32 v71, v15, v31, s79
    s_mov_b32 s81, s64
    s_add_u32 s64, s64, 0x20000
    s_mov_b32 s70, 1600000
LW_17:
    ds_read_b32 v59, v61 offset:4104
    s_waitcnt lgkmcnt(0)
    v_readfirstlane_b32 s71, v59
    s_cmp_ge_u32 s71, 2048
    s_cbranch_scc1 LWD_18
    s_sleep 16
    s_sub_u32 s70, s70, 1
    s_cmp_lg_u32 s70, 0
    s_cbranch_scc1 LW_17
LWD_18:
    ds_read_b128 v[32:35], v61 offset:21760
    ds_read_b128 v[12:15], v61 offset:21776
    ds_read_b128 v[16:19], v61 offset:21792
    ds_read_b128 v[20:23], v61 offset:21808
    ds_read_b128 v[24:27], v61 offset:21824
    ds_read_b128 v[44:47], v36 offset:19712
    ds_read_b128 v[48:51], v36 offset:20224
    ds_read_b128 v[52:55], v36 offset:20736
    ds_read_b128 v[56:59], v36 offset:21248
    s_waitcnt lgkmcnt(8)
    v_max3_f32 v28, v32, v33, v34
    v_max_f32 v28, v28, v35
    v_sub_f32 v32, v32, v28
    v_sub_f32 v33, v33, v28
    v_sub_f32 v34, v34, v28
    v_sub_f32 v35, v35, v28
    v_mul_f32 v32, s75, v32
    v_mul_f32 v33, s75, v33
    v_mul_f32 v34, s75, v34
    v_mul_f32 v35, s75, v35
    v_exp_f32 v32, v32
    v_exp_f32 v33, v33
    v_exp_f32 v34, v34
    v_exp_f32 v35, v35
    s_waitcnt lgkmcnt(4)
    v_add_f32 v12, v12, v13
    v_add_f32 v14, v14, v15
    v_add_f32 v12, v12, v14
    v_add_f32 v16, v16, v17
    v_add_f32 v18, v18, v19
    v_add_f32 v16, v16, v18
    v_add_f32 v20, v20, v21
    v_add_f32 v22, v22, v23
    v_add_f32 v20, v20, v22
    v_add_f32 v24, v24, v25
    v_add_f32 v26, v26, v27
    v_add_f32 v24, v24, v26
    v_mul_f32 v29, v12, v32
    v_fmac_f32 v29, v16, v33
    v_fmac_f32 v29, v20, v34
    v_fmac_f32 v29, v24, v35
    v_rcp_f32 v30, v29
    v_log_f32 v31, v29
    s_waitcnt lgkmcnt(0)
    v_mul_f32 v12, v44, v32
    v_mul_f32 v13, v45, v32
    v_mul_f32 v14, v46, v32
    v_mul_f32 v15, v47, v32
    v_fmac_f32 v12, v48, v33
    v_fmac_f32 v13, v49, v33
    v_fmac_f32 v14, v50, v33
    v_fmac_f32 v15, v51, v33
    v_fmac_f32 v12, v52, v34
    v_fmac_f32 v13, v53, v34
    v_fmac_f32 v14, v54, v34
    v_fmac_f32 v15, v55, v34
    v_fmac_f32 v12, v56, v35
    v_fmac_f32 v13, v57, v35
    v_fmac_f32 v14, v58, v35
    v_fmac_f32 v15, v59, v35
    v_fmac_f32 v31, s75, v28
    v_mul_f32 v12, v12, v30
    v_mul_f32 v13, v13, v30
    v_mul_f32 v14, v14, v30
    v_mul_f32 v15, v15, v30
    v_perm_b32 v31, s94, v31, v37
    v_perm_b32 v72, v12, v31, s76
    v_perm_b32 v73, v13, v31, s77
    v_perm_b32 v74, v14, v31, s78
    v_perm_b32 v75, v15, v31, s79
    s_mov_b32 s82, s64
    s_mov_b32 s70, 1600000
LW_19:
    ds_read_b32 v59, v61 offset:4128
    s_waitcnt lgkmcnt(0)
    v_readfirstlane_b32 s71, v59
    s_cmp_ge_u32 s71, 992
    s_cbranch_scc1 LWD_20
    s_sleep 16
    s_sub_u32 s70, s70, 1
    s_cmp_lg_u32 s70, 0
    s_cbranch_scc1 LW_19
LWD_20:
    s_mov_b32 s70, 1600000
TW_21:
    ds_read_b64 v[58:59], v61 offset:4128
    s_waitcnt lgkmcnt(0)
    v_readfirstlane_b32 s71, v58
    v_readfirstlane_b32 s72, v59
    s_add_u32 s71, s71, 8
    s_cmp_ge_u32 s71, s72
    s_cbranch_scc1 TWD_22
    s_sleep 2
    s_sub_u32 s70, s70, 1
    s_cmp_lg_u32 s70, 0
    s_cbranch_scc1 TW_21
TWD_22:
    s_mov_b32 exec_hi, 0
    buffer_store_dwordx4 v[64:67], v40, s[24:27], s80 offen sc1
    s_mov_b32 exec_hi, -1
    s_mov_b32 exec_hi, 0
    buffer_store_dwordx4 v[68:71], v40, s[24:27], s81 offen sc1
    s_mov_b32 exec_hi, -1
    s_mov_b32 exec_hi, 0
    buffer_store_dwordx4 v[72:75], v40, s[24:27], s82 offen sc1
    s_mov_b32 exec_hi, -1
    s_branch L_WO
L_S1:
    v_and_b32 v12, 0xffffff00, v38
    v_and_b32 v13, 0xffffff00, v38
    v_and_b32 v14, 0xffffff00, v38
    v_and_b32 v15, 0xffffff00, v38
    s_lshl_b32 s60, s100, 8
    s_add_u32 s60, s60, 3735552
    s_cmp_eq_u32 s4, 0
    s_cselect_b32 exec_lo, 0xff, 0
    s_mov_b32 exec_hi, 0
    s_cbranch_execz L_NOZ
    buffer_store_dwordx4 v[12:15], v40, s[24:27], s60 offen sc1
L_NOZ:
    s_mov_b64 exec, -1
    s_lshl_b32 s64, s59, 5
    s_add_u32 s64, s64, s4
    s_lshl_b32 s64, s64, 9
    s_add_u32 s64, s64, 524288
    s_mov_b32 s70, 1600000
LW_23:
    ds_read_b32 v59, v61 offset:4112
    s_waitcnt lgkmcnt(0)
    v_readfirstlane_b32 s71, v59
    s_cmp_ge_u32 s71, 512
    s_cbranch_scc1 LWD_24
    s_sleep 16
    s_sub_u32 s70, s70, 1
    s_cmp_lg_u32 s70, 0
    s_cbranch_scc1 LW_23
LWD_24:
    ds_read_b128 v[32:35], v61 offset:26112
    ds_read_b128 v[12:15], v61 offset:26128
    ds_read_b128 v[16:19], v61 offset:26144
    ds_read_b128 v[20:23], v61 offset:26160
    ds_read_b128 v[24:27], v61 offset:26176
    ds_read_b128 v[44:47], v36 offset:24064
    ds_read_b128 v[48:51], v36 offset:24576
    ds_read_b128 v[52:55], v36 offset:25088
    ds_read_b128 v[56:59], v36 offset:25600
    s_waitcnt lgkmcnt(8)
    v_max3_f32 v28, v32, v33, v34
    v_max_f32 v28, v28, v35
    v_sub_f32 v32, v32, v28
    v_sub_f32 v33, v33, v28
    v_sub_f32 v34, v34, v28
    v_sub_f32 v35, v35, v28
    v_mul_f32 v32, s75, v32
    v_mul_f32 v33, s75, v33
    v_mul_f32 v34, s75, v34
    v_mul_f32 v35, s75, v35
    v_exp_f32 v32, v32
    v_exp_f32 v33, v33
    v_exp_f32 v34, v34
    v_exp_f32 v35, v35
    s_waitcnt lgkmcnt(4)
    v_add_f32 v12, v12, v13
    v_add_f32 v14, v14, v15
    v_add_f32 v12, v12, v14
    v_add_f32 v16, v16, v17
    v_add_f32 v18, v18, v19
    v_add_f32 v16, v16, v18
    v_add_f32 v20, v20, v21
    v_add_f32 v22, v22, v23
    v_add_f32 v20, v20, v22
    v_add_f32 v24, v24, v25
    v_add_f32 v26, v26, v27
    v_add_f32 v24, v24, v26
    v_mul_f32 v29, v12, v32
    v_fmac_f32 v29, v16, v33
    v_fmac_f32 v29, v20, v34
    v_fmac_f32 v29, v24, v35
    v_rcp_f32 v30, v29
    v_log_f32 v31, v29
    s_waitcnt lgkmcnt(0)
    v_mul_f32 v12, v44, v32
    v_mul_f32 v13, v45, v32
    v_mul_f32 v14, v46, v32
    v_mul_f32 v15, v47, v32
    v_fmac_f32 v12, v48, v33
    v_fmac_f32 v13, v49, v33
    v_fmac_f32 v14, v50, v33
    v_fmac_f32 v15, v51, v33
    v_fmac_f32 v12, v52, v34
    v_fmac_f32 v13, v53, v34
    v_fmac_f32 v14, v54, v34
    v_fmac_f32 v15, v55, v34
    v_fmac_f32 v12, v56, v35
    v_fmac_f32 v13, v57, v35
    v_fmac_f32 v14, v58, v35
    v_fmac_f32 v15, v59, v35
    v_fmac_f32 v31, s75, v28
    v_mul_f32 v12, v12, v30
    v_mul_f32 v13, v13, v30
    v_mul_f32 v14, v14, v30
    v_mul_f32 v15, v15, v30
    v_perm_b32 v31, s94, v31, v37
    v_perm_b32 v64, v12, v31, s76
    v_perm_b32 v65, v13, v31, s77
    v_perm_b32 v66, v14, v31, s78
    v_perm_b32 v67, v15, v31, s79
    s_mov_b32 s80, s64
    s_add_u32 s64, s64, 0x1000
    ds_read_b128 v[32:35], v61 offset:28288
    ds_read_b128 v[12:15], v61 offset:28304
    ds_read_b128 v[16:19], v61 offset:28320
    ds_read_b128 v[20:23], v61 offset:28336
    ds_read_b128 v[24:27], v61 offset:28352
    ds_read_b128 v[44:47], v36 offset:26240
    ds_read_b128 v[48:51], v36 offset:26752
    ds_read_b128 v[52:55], v36 offset:27264
    ds_read_b128 v[56:59], v36 offset:27776
    s_waitcnt lgkmcnt(8)
    v_max3_f32 v28, v32, v33, v34
    v_max_f32 v28, v28, v35
    v_sub_f32 v32, v32, v28
    v_sub_f32 v33, v33, v28
    v_sub_f32 v34, v34, v28
    v_sub_f32 v35, v35, v28
    v_mul_f32 v32, s75, v32
    v_mul_f32 v33, s75, v33
    v_mul_f32 v34, s75, v34
    v_mul_f32 v35, s75, v35
    v_exp_f32 v32, v32
    v_exp_f32 v33, v33
    v_exp_f32 v34, v34
    v_exp_f32 v35, v35
    s_waitcnt lgkmcnt(4)
    v_add_f32 v12, v12, v13
    v_add_f32 v14, v14, v15
    v_add_f32 v12, v12, v14
    v_add_f32 v16, v16, v17
    v_add_f32 v18, v18, v19
    v_add_f32 v16, v16, v18
    v_add_f32 v20, v20, v21
    v_add_f32 v22, v22, v23
    v_add_f32 v20, v20, v22
    v_add_f32 v24, v24, v25
    v_add_f32 v26, v26, v27
    v_add_f32 v24, v24, v26
    v_mul_f32 v29, v12, v32
    v_fmac_f32 v29, v16, v33
    v_fmac_f32 v29, v20, v34
    v_fmac_f32 v29, v24, v35
    v_rcp_f32 v30, v29
    v_log_f32 v31, v29
    s_waitcnt lgkmcnt(0)
    v_mul_f32 v12, v44, v32
    v_mul_f32 v13, v45, v32
    v_mul_f32 v14, v46, v32
    v_mul_f32 v15, v47, v32
    v_fmac_f32 v12, v48, v33
    v_fmac_f32 v13, v49, v33
    v_fmac_f32 v14, v50, v33
    v_fmac_f32 v15, v51, v33
    v_fmac_f32 v12, v52, v34
    v_fmac_f32 v13, v53, v34
    v_fmac_f32 v14, v54, v34
    v_fmac_f32 v15, v55, v34
    v_fmac_f32 v12, v56, v35
    v_fmac_f32 v13, v57, v35
    v_fmac_f32 v14, v58, v35
    v_fmac_f32 v15, v59, v35
    v_fmac_f32 v31, s75, v28
    v_mul_f32 v12, v12, v30
    v_mul_f32 v13, v13, v30
    v_mul_f32 v14, v14, v30
    v_mul_f32 v15, v15, v30
    v_perm_b32 v31, s94, v31, v37
    v_perm_b32 v68, v12, v31, s76
    v_perm_b32 v69, v13, v31, s77
    v_perm_b32 v70, v14, v31, s78
    v_perm_b32 v71, v15, v31, s79
    s_mov_b32 s81, s64
    s_add_u32 s64, s64, 0x1000
    ds_read_b128 v[32:35], v61 offset:30464
    ds_read_b128 v[12:15], v61 offset:30480
    ds_read_b128 v[16:19], v61 offset:30496
    ds_read_b128 v[20:23], v61 offset:30512
    ds_read_b128 v[24:27], v61 offset:30528
    ds_read_b128 v[44:47], v36 offset:28416
    ds_read_b128 v[48:51], v36 offset:28928
    ds_read_b128 v[52:55], v36 offset:29440
    ds_read_b128 v[56:59], v36 offset:29952
    s_waitcnt lgkmcnt(8)
    v_max3_f32 v28, v32, v33, v34
    v_max_f32 v28, v28, v35
    v_sub_f32 v32, v32, v28
    v_sub_f32 v33, v33, v28
    v_sub_f32 v34, v34, v28
    v_sub_f32 v35, v35, v28
    v_mul_f32 v32, s75, v32
    v_mul_f32 v33, s75, v33
    v_mul_f32 v34, s75, v34
    v_mul_f32 v35, s75, v35
    v_exp_f32 v32, v32
    v_exp_f32 v33, v33
    v_exp_f32 v34, v34
    v_exp_f32 v35, v35
    s_waitcnt lgkmcnt(4)
    v_add_f32 v12, v12, v13
    v_add_f32 v14, v14, v15
    v_add_f32 v12, v12, v14
    v_add_f32 v16, v16, v17
    v_add_f32 v18, v18, v19
    v_add_f32 v16, v16, v18
    v_add_f32 v20, v20, v21
    v_add_f32 v22, v22, v23
    v_add_f32 v20, v20, v22
    v_add_f32 v24, v24, v25
    v_add_f32 v26, v26, v27
    v_add_f32 v24, v24, v26
    v_mul_f32 v29, v12, v32
    v_fmac_f32 v29, v16, v33
    v_fmac_f32 v29, v20, v34
    v_fmac_f32 v29, v24, v35
    v_rcp_f32 v30, v29
    v_log_f32 v31, v29
    s_waitcnt lgkmcnt(0)
    v_mul_f32 v12, v44, v32
    v_mul_f32 v13, v45, v32
    v_mul_f32 v14, v46, v32
    v_mul_f32 v15, v47, v32
    v_fmac_f32 v12, v48, v33
    v_fmac_f32 v13, v49, v33
    v_fmac_f32 v14, v50, v33
    v_fmac_f32 v15, v51, v33
    v_fmac_f32 v12, v52, v34
    v_fmac_f32 v13, v53, v34
    v_fmac_f32 v14, v54, v34
    v_fmac_f32 v15, v55, v34
    v_fmac_f32 v12, v56, v35
    v_fmac_f32 v13, v57, v35
    v_fmac_f32 v14, v58, v35
    v_fmac_f32 v15, v59, v35
    v_fmac_f32 v31, s75, v28
    v_mul_f32 v12, v12, v30
    v_mul_f32 v13, v13, v30
    v_mul_f32 v14, v14, v30
    v_mul_f32 v15, v15, v30
    v_perm_b32 v31, s94, v31, v37
    v_perm_b32 v72, v12, v31, s76
    v_perm_b32 v73, v13, v31, s77
    v_perm_b32 v74, v14, v31, s78
    v_perm_b32 v75, v15, v31, s79
    s_mov_b32 s82, s64
    s_add_u32 s64, s64, 0x1000
    ds_read_b128 v[32:35], v61 offset:32640
    ds_read_b128 v[12:15], v61 offset:32656
    ds_read_b128 v[16:19], v61 offset:32672
    ds_read_b128 v[20:23], v61 offset:32688
    ds_read_b128 v[24:27], v61 offset:32704
    ds_read_b128 v[44:47], v36 offset:30592
    ds_read_b128 v[48:51], v36 offset:31104
    ds_read_b128 v[52:55], v36 offset:31616
    ds_read_b128 v[56:59], v36 offset:32128
    s_waitcnt lgkmcnt(8)
    v_max3_f32 v28, v32, v33, v34
    v_max_f32 v28, v28, v35
    v_sub_f32 v32, v32, v28
    v_sub_f32 v33, v33, v28
    v_sub_f32 v34, v34, v28
    v_sub_f32 v35, v35, v28
    v_mul_f32 v32, s75, v32
    v_mul_f32 v33, s75, v33
    v_mul_f32 v34, s75, v34
    v_mul_f32 v35, s75, v35
    v_exp_f32 v32, v32
    v_exp_f32 v33, v33
    v_exp_f32 v34, v34
    v_exp_f32 v35, v35
    s_waitcnt lgkmcnt(4)
    v_add_f32 v12, v12, v13
    v_add_f32 v14, v14, v15
    v_add_f32 v12, v12, v14
    v_add_f32 v16, v16, v17
    v_add_f32 v18, v18, v19
    v_add_f32 v16, v16, v18
    v_add_f32 v20, v20, v21
    v_add_f32 v22, v22, v23
    v_add_f32 v20, v20, v22
    v_add_f32 v24, v24, v25
    v_add_f32 v26, v26, v27
    v_add_f32 v24, v24, v26
    v_mul_f32 v29, v12, v32
    v_fmac_f32 v29, v16, v33
    v_fmac_f32 v29, v20, v34
    v_fmac_f32 v29, v24, v35
    v_rcp_f32 v30, v29
    v_log_f32 v31, v29
    s_waitcnt lgkmcnt(0)
    v_mul_f32 v12, v44, v32
    v_mul_f32 v13, v45, v32
    v_mul_f32 v14, v46, v32
    v_mul_f32 v15, v47, v32
    v_fmac_f32 v12, v48, v33
    v_fmac_f32 v13, v49, v33
    v_fmac_f32 v14, v50, v33
    v_fmac_f32 v15, v51, v33
    v_fmac_f32 v12, v52, v34
    v_fmac_f32 v13, v53, v34
    v_fmac_f32 v14, v54, v34
    v_fmac_f32 v15, v55, v34
    v_fmac_f32 v12, v56, v35
    v_fmac_f32 v13, v57, v35
    v_fmac_f32 v14, v58, v35
    v_fmac_f32 v15, v59, v35
    v_fmac_f32 v31, s75, v28
    v_mul_f32 v12, v12, v30
    v_mul_f32 v13, v13, v30
    v_mul_f32 v14, v14, v30
    v_mul_f32 v15, v15, v30
    v_perm_b32 v31, s94, v31, v37
    v_perm_b32 v76, v12, v31, s76
    v_perm_b32 v77, v13, v31, s77
    v_perm_b32 v78, v14, v31, s78
    v_perm_b32 v79, v15, v31, s79
    s_mov_b32 s83, s64
    s_mov_b32 s70, 1600000
LW_25:
    ds_read_b32 v59, v61 offset:4128
    s_waitcnt lgkmcnt(0)
    v_readfirstlane_b32 s71, v59
    s_cmp_ge_u32 s71, 992
    s_cbranch_scc1 LWD_26
    s_sleep 32
    s_sub_u32 s70, s70, 1
    s_cmp_lg_u32 s70, 0
    s_cbranch_scc1 LW_25
LWD_26:
    s_mov_b32 s70, 1600000
TW_27:
    ds_read_b64 v[58:59], v61 offset:4128
    s_waitcnt lgkmcnt(0)
    v_readfirstlane_b32 s71, v58
    v_readfirstlane_b32 s72, v59
    s_add_u32 s71, s71, 8
    s_cmp_ge_u32 s71, s72
    s_cbranch_scc1 TWD_28
    s_sleep 2
    s_sub_u32 s70, s70, 1
    s_cmp_lg_u32 s70, 0
    s_cbranch_scc1 TW_27
TWD_28:
    s_mov_b32 exec_hi, 0
    buffer_store_dwordx4 v[64:67], v40, s[24:27], s80 offen sc1
    s_mov_b32 exec_hi, -1
    s_mov_b32 exec_hi, 0
    buffer_store_dwordx4 v[68:71], v40, s[24:27], s81 offen sc1
    s_mov_b32 exec_hi, -1
    s_mov_b32 exec_hi, 0
    buffer_store_dwordx4 v[72:75], v40, s[24:27], s82 offen sc1
    s_mov_b32 exec_hi, -1
    s_mov_b32 exec_hi, 0
    buffer_store_dwordx4 v[76:79], v40, s[24:27], s83 offen sc1
    s_mov_b32 exec_hi, -1
    s_branch L_WO
L_QF:
    s_mov_b32 s70, 1600000
LW_29:
    ds_read_b32 v59, v61 offset:4128
    s_waitcnt lgkmcnt(0)
    v_readfirstlane_b32 s71, v59
    s_cmp_ge_u32 s71, 256
    s_cbranch_scc1 LWD_30
    s_sleep 16
    s_sub_u32 s70, s70, 1
    s_cmp_lg_u32 s70, 0
    s_cbranch_scc1 LW_29
LWD_30:
    s_lshl_b32 s60, s100, 10
    s_add_u32 s60, s60, 2719744
    s_lshl_b32 s61, s59, 12
    s_add_u32 s61, s61, 2752512
    s_mov_b32 s70, 100000
    s_branch L_QPXX
L_QPX:
    s_sleep 8
L_QPXX:
    buffer_load_dwordx4 v[192:195], v40, s[24:27], s60 offen sc1
    buffer_load_dwordx4 v[196:199], v40, s[24:27], s61 offen offset:0 sc1
    buffer_load_dwordx4 v[200:203], v40, s[24:27], s61 offen offset:1024 sc1
    buffer_load_dwordx4 v[204:207], v40, s[24:27], s61 offen offset:2048 sc1
    buffer_load_dwordx4 v[208:211], v40, s[24:27], s61 offen offset:3072 sc1
    s_waitcnt vmcnt(4)
    v_perm_b32 v56, v193, v192, s66
    v_perm_b32 v57, v195, v194, s66
    v_lshl_or_b32 v56, v57, 16, v56
    v_xor_b32 v58, s94, v56
    s_waitcnt vmcnt(3)
    v_perm_b32 v56, v197, v196, s66
    v_perm_b32 v57, v199, v198, s66
    v_lshl_or_b32 v56, v57, 16, v56
    v_xor_b32 v56, s94, v56
    v_or_b32 v58, v58, v56
    s_waitcnt vmcnt(2)
    v_perm_b32 v56, v201, v200, s66
    v_perm_b32 v57, v203, v202, s66
    v_lshl_or_b32 v56, v57, 16, v56
    v_xor_b32 v56, s94, v56
    v_or_b32 v58, v58, v56
    s_waitcnt vmcnt(1)
    v_perm_b32 v56, v205, v204, s66
    v_perm_b32 v57, v207, v206, s66
    v_lshl_or_b32 v56, v57, 16, v56
    v_xor_b32 v56, s94, v56
    v_or_b32 v58, v58, v56
    s_waitcnt vmcnt(0)
    v_perm_b32 v56, v209, v208, s66
    v_perm_b32 v57, v211, v210, s66
    v_lshl_or_b32 v56, v57, 16, v56
    v_xor_b32 v56, s94, v56
    v_or_b32 v58, v58, v56
    v_cmp_ne_u32 vcc, 0, v58
    s_cbranch_vccz L_QPDX
    s_sub_u32 s70, s70, 1
    s_cmp_lg_u32 s70, 0
    s_cbranch_scc1 L_QPX
L_QPDX:
    v_and_b32 v192, v31, v192
    v_and_b32 v193, v31, v193
    v_and_b32 v194, v31, v194
    v_and_b32 v195, v31, v195
    s_nop 0
    v_permlane32_swap_b32 v192, v194
    v_permlane32_swap_b32 v193, v195
    v_add_f32 v192, v192, v194
    v_add_f32 v193, v193, v195
    v_cvt_pk_bf16_f32 v192, v192, v193
    v_and_b32 v196, v31, v196
    v_and_b32 v197, v31, v197
    v_and_b32 v198, v31, v198
    v_and_b32 v199, v31, v199
    s_nop 0
    v_permlane32_swap_b32 v196, v198
    v_permlane32_swap_b32 v197, v199
    v_add_f32 v196, v196, v198
    v_add_f32 v197, v197, v199
    v_cvt_pk_bf16_f32 v196, v196, v197
    v_and_b32 v200, v31, v200
    v_and_b32 v201, v31, v201
    v_and_b32 v202, v31, v202
    v_and_b32 v203, v31, v203
    s_nop 0
    v_permlane32_swap_b32 v200, v202
    v_permlane32_swap_b32 v201, v203
    v_add_f32 v200, v200, v202
    v_add_f32 v201, v201, v203
    v_cvt_pk_bf16_f32 v200, v200, v201
    v_and_b32 v204, v31, v204
    v_and_b32 v205, v31, v205
    v_and_b32 v206, v31, v206
    v_and_b32 v207, v31, v207
    s_nop 0
    v_permlane32_swap_b32 v204, v206
    v_permlane32_swap_b32 v205, v207
    v_add_f32 v204, v204, v206
    v_add_f32 v205, v205, v207
    v_cvt_pk_bf16_f32 v204, v204, v205
    v_and_b32 v208, v31, v208
    v_and_b32 v209, v31, v209
    v_and_b32 v210, v31, v210
    v_and_b32 v211, v31, v211
    s_nop 0
    v_permlane32_swap_b32 v208, v210
    v_permlane32_swap_b32 v209, v211
    v_add_f32 v208, v208, v210
    v_add_f32 v209, v209, v211
    v_cvt_pk_bf16_f32 v208, v208, v209
    ds_write_b32 v30, v192 offset:14080
    ds_write_b32 v30, v196 offset:14336
    ds_write_b32 v30, v200 offset:14592
    ds_write_b32 v30, v204 offset:14848
    ds_write_b32 v30, v208 offset:15104
    s_lshl_b32 s60, s59, 21
    s_lshl_b32 s61, s4, 16
    s_add_u32 s60, s60, s61
    s_add_u32 s60, s60, 1573957
    s_and_b32 s61, s59, 2
    s_lshl_b32 s61, s61, 13
    s_add_u32 s60, s60, s61
    s_lshl_b32 s61, s100, 21
    s_mul_i32 s62, s4, 163840
    s_add_u32 s61, s61, s62
    s_add_u32 s61, s61, 201327669
    v_subrev_u32 v45, 8, v0
    v_cmp_le_u32 vcc, 28, v0
    s_nop 1
    v_cndmask_b32 v45, v0, v45, vcc
    v_and_b32 v44, 3, v45
    v_lshlrev_b32 v44, 12, v44
    v_bfe_i32 v47, v45, 2, 1
    v_and_b32 v47, 0x8100, v47
    v_xor_b32 v44, v44, v47
    v_bfe_i32 v47, v45, 3, 1
    v_and_b32 v47, 0x10200, v47
    v_xor_b32 v44, v44, v47
    v_bfe_i32 v47, v45, 4, 1
    v_and_b32 v47, 0x20800, v47
    v_xor_b32 v44, v44, v47
    v_add_u32 v44, s61, v44
    v_subrev_u32 v45, 20, v0
    v_and_b32 v46, 3, v45
    v_lshlrev_b32 v46, 12, v46
    v_bfe_i32 v47, v45, 2, 1
    v_and_b32 v47, 0x8100, v47
    v_xor_b32 v46, v46, v47
    v_bfe_i32 v47, v45, 3, 1
    v_and_b32 v47, 0x10200, v47
    v_xor_b32 v46, v46, v47
    v_bfe_i32 v47, v45, 4, 1
    v_and_b32 v47, 0x20800, v47
    v_xor_b32 v46, v46, v47
    v_add_u32 v46, s60, v46
    v_cmp_gt_u32 vcc, 8, v45
    s_nop 1
    v_cndmask_b32 v44, v44, v46, vcc
    v_lshlrev_b32 v45, 2, v0
    s_mov_b32 exec_lo, 0xfffffff
    s_mov_b32 exec_hi, 0x0
    ds_write_b32 v45, v44 offset:384
    s_mov_b64 exec, -1
    s_waitcnt lgkmcnt(0)
    s_mov_b32 s70, 1600000
LW_31:
    ds_read_b32 v59, v61 offset:4128
    s_waitcnt lgkmcnt(0)
    v_readfirstlane_b32 s71, v59
    s_cmp_ge_u32 s71, 992
    s_cbranch_scc1 LWD_32
    s_sleep 64
    s_sub_u32 s70, s70, 1
    s_cmp_lg_u32 s70, 0
    s_cbranch_scc1 LW_31
LWD_32:
    s_branch L_WO
L_DISP:
    s_mov_b32 s48, 992
    s_lshl_b32 s50, s100, 8
    s_add_u32 s50, s50, 3735552
    s_mov_b32 s51, 192
    s_lshl_b32 s52, s100, 21
    s_add_u32 s52, s52, 202637361
    s_sub_u32 s49, s48, 12
    s_mov_b32 s70, 1600000
LW_33:
    ds_read_b32 v59, v61 offset:4128
    s_waitcnt lgkmcnt(0)
    v_readfirstlane_b32 s71, v59
    s_cmp_ge_u32 s71, 916
    s_cbranch_scc1 LWD_34
    s_sleep 32
    s_sub_u32 s70, s70, 1
    s_cmp_lg_u32 s70, 0
    s_cbranch_scc1 LW_33
LWD_34:
    s_and_b32 s54, s94, 0xffffff00
    s_mov_b32 s70, 100000
L_CP:
    s_mov_b64 exec, 1
    buffer_load_dword v59, off, s[24:27], s50 sc0 sc1
    s_mov_b64 exec, -1
    s_waitcnt vmcnt(0)
    v_readfirstlane_b32 s71, v59
    s_sub_u32 s71, s71, s54
    s_cmp_lt_u32 s71, 1024
    s_cbranch_scc1 L_CPD
    s_sleep 32
    s_sub_u32 s70, s70, 1
    s_cmp_lg_u32 s70, 0
    s_cbranch_scc1 L_CP
L_CPD:
    s_mov_b32 s70, 1600000
LW_35:
    ds_read_b32 v59, v61 offset:4128
    s_waitcnt lgkmcnt(0)
    v_readfirstlane_b32 s71, v59
    s_cmp_ge_u32 s71, 964
    s_cbranch_scc1 LWD_36
    s_sleep 8
    s_sub_u32 s70, s70, 1
    s_cmp_lg_u32 s70, 0
    s_cbranch_scc1 LW_35
LWD_36:
    v_lshlrev_b32 v46, 12, v0
    v_lshlrev_b32 v47, 2, v0
    s_mov_b32 s53, 0
    s_mov_b32 s70, 1600000
L_DA:
DW_37:
    ds_read_b32 v44, v61 offset:4128
    s_waitcnt lgkmcnt(0)
    v_readfirstlane_b32 s71, v44
    s_cmp_ge_u32 s71, s49
    s_cbranch_scc1 DG_38
    s_sleep 2
    s_sub_u32 s70, s70, 1
    s_cbranch_scc0 DW_37
    s_branch L_DXA
DG_38:
    s_mov_b64 exec, 1
    v_mov_b32 v100, 1
    buffer_atomic_add v100, off, s[24:27], s50 sc0 sc1
    s_mov_b64 exec, -1
    s_add_u32 s49, s49, 4
    s_add_u32 s53, s53, 1
    s_cmp_lt_u32 s53, 3
    s_cbranch_scc1 DN_39
    s_waitcnt vmcnt(2)
    v_readfirstlane_b32 s71, v101
    s_sub_u32 s71, s71, s54
    s_cmp_ge_u32 s71, s51
    s_cbranch_scc1 L_DXA
    s_cmp_ge_u32 s71, 128
    s_cselect_b32 s72, 2, 0
    s_cmp_ge_u32 s71, 176
    s_cselect_b32 s73, s48, -1
    v_mov_b32 v48, s73
    s_lshl_b32 s71, s71, 12
    s_add_u32 s71, s71, s52
    s_or_b32 s71, s71, s72
    v_add_u32 v44, s71, v46
    v_add_u32 v45, s48, v47
    s_mov_b64 exec, 1
    ds_write_b32 v45, v44
    ds_min_u32 v61, v48 offset:4132
    s_mov_b64 exec, -1
    s_add_u32 s48, s48, 4
DN_39:
DW_40:
    ds_read_b32 v44, v61 offset:4128
    s_waitcnt lgkmcnt(0)
    v_readfirstlane_b32 s71, v44
    s_cmp_ge_u32 s71, s49
    s_cbranch_scc1 DG_41
    s_sleep 2
    s_sub_u32 s70, s70, 1
    s_cbranch_scc0 DW_40
    s_branch L_DXA
DG_41:
    s_mov_b64 exec, 1
    v_mov_b32 v101, 1
    buffer_atomic_add v101, off, s[24:27], s50 sc0 sc1
    s_mov_b64 exec, -1
    s_add_u32 s49, s49, 4
    s_add_u32 s53, s53, 1
    s_cmp_lt_u32 s53, 3
    s_cbranch_scc1 DN_42
    s_waitcnt vmcnt(2)
    v_readfirstlane_b32 s71, v102
    s_sub_u32 s71, s71, s54
    s_cmp_ge_u32 s71, s51
    s_cbranch_scc1 L_DXA
    s_cmp_ge_u32 s71, 128
    s_cselect_b32 s72, 2, 0
    s_cmp_ge_u32 s71, 176
    s_cselect_b32 s73, s48, -1
    v_mov_b32 v48, s73
    s_lshl_b32 s71, s71, 12
    s_add_u32 s71, s71, s52
    s_or_b32 s71, s71, s72
    v_add_u32 v44, s71, v46
    v_add_u32 v45, s48, v47
    s_mov_b64 exec, 1
    ds_write_b32 v45, v44
    ds_min_u32 v61, v48 offset:4132
    s_mov_b64 exec, -1
    s_add_u32 s48, s48, 4
DN_42:
DW_43:
    ds_read_b32 v44, v61 offset:4128
    s_waitcnt lgkmcnt(0)
    v_readfirstlane_b32 s71, v44
    s_cmp_ge_u32 s71, s49
    s_cbranch_scc1 DG_44
    s_sleep 2
    s_sub_u32 s70, s70, 1
    s_cbranch_scc0 DW_43
    s_branch L_DXA
DG_44:
    s_mov_b64 exec, 1
    v_mov_b32 v102, 1
    buffer_atomic_add v102, off, s[24:27], s50 sc0 sc1
    s_mov_b64 exec, -1
    s_add_u32 s49, s49, 4
    s_add_u32 s53, s53, 1
    s_cmp_lt_u32 s53, 3
    s_cbranch_scc1 DN_45
    s_waitcnt vmcnt(2)
    v_readfirstlane_b32 s71, v100
    s_sub_u32 s71, s71, s54
    s_cmp_ge_u32 s71, s51
    s_cbranch_scc1 L_DXA
    s_cmp_ge_u32 s71, 128
    s_cselect_b32 s72, 2, 0
    s_cmp_ge_u32 s71, 176
    s_cselect_b32 s73, s48, -1
    v_mov_b32 v48, s73
    s_lshl_b32 s71, s71, 12
    s_add_u32 s71, s71, s52
    s_or_b32 s71, s71, s72
    v_add_u32 v44, s71, v46
    v_add_u32 v45, s48, v47
    s_mov_b64 exec, 1
    ds_write_b32 v45, v44
    ds_min_u32 v61, v48 offset:4132
    s_mov_b64 exec, -1
    s_add_u32 s48, s48, 4
DN_45:
    s_branch L_DA
L_DXA:
    v_lshlrev_b32 v53, 2, v0
    v_add_u32 v53, s48, v53
    v_mov_b32 v52, 0xf0000081
    s_mov_b32 exec_hi, 0
    ds_write_b32 v53, v52
    s_mov_b64 exec, 1
    ds_add_u32 v61, v60 offset:4116
    v_mov_b32 v52, s48
    ds_min_u32 v61, v52 offset:4132
    s_mov_b64 exec, -1
    s_waitcnt vmcnt(0) lgkmcnt(0)
L_WO:
    s_mov_b32 s70, 1600000
TW_46:
    ds_read_b64 v[58:59], v61 offset:4128
    s_waitcnt lgkmcnt(0)
    v_readfirstlane_b32 s71, v58
    v_readfirstlane_b32 s72, v59
    s_cmp_ge_u32 s71, s72
    s_cbranch_scc1 TWD_47
    s_sleep 2
    s_sub_u32 s70, s70, 1
    s_cmp_lg_u32 s70, 0
    s_cbranch_scc1 TW_46
TWD_47:
L_WO2:
    buffer_load_dwordx4 v[192:195], v80, s[12:15], s86 offen offset:0 nt
    buffer_load_dwordx4 v[196:199], v80, s[12:15], s86 offen offset:1024 nt
    buffer_load_dwordx4 v[200:203], v80, s[12:15], s86 offen offset:2048 nt
    buffer_load_dwordx4 v[204:207], v80, s[12:15], s86 offen offset:3072 nt
    buffer_load_dwordx4 v[208:211], v80, s[12:15], s87 offen offset:0 nt
    buffer_load_dwordx4 v[212:215], v80, s[12:15], s87 offen offset:1024 nt
    buffer_load_dwordx4 v[216:219], v80, s[12:15], s87 offen offset:2048 nt
    buffer_load_dwordx4 v[220:223], v80, s[12:15], s87 offen offset:3072 nt
    s_cmp_eq_u32 s91, 0
    s_cbranch_scc1 L_GOW
    s_lshr_b32 s66, s90, 4
    s_lshl_b32 s66, s66, 10
    buffer_load_dwordx4 v[128:131], v40, s[8:11], s66 offen
    buffer_load_dwordx4 v[132:135], v40, s[16:19], 0 offen
    s_waitcnt vmcnt(0)
    v_lshlrev_b32 v20, 16, v128
    v_and_b32 v21, 0xffff0000, v128
    v_lshlrev_b32 v22, 16, v132
    v_and_b32 v23, 0xffff0000, v132
    v_mul_f32 v20, v20, v22
    v_mul_f32 v21, v21, v23
    v_cvt_pk_bf16_f32 v20, v20, v21
    v_lshlrev_b32 v21, 16, v20
    v_and_b32 v20, 0xffff0000, v20
    v_add_f32 v24, v20, v21
    v_lshlrev_b32 v20, 16, v129
    v_and_b32 v21, 0xffff0000, v129
    v_lshlrev_b32 v22, 16, v133
    v_and_b32 v23, 0xffff0000, v133
    v_mul_f32 v20, v20, v22
    v_mul_f32 v21, v21, v23
    v_cvt_pk_bf16_f32 v20, v20, v21
    v_lshlrev_b32 v21, 16, v20
    v_and_b32 v20, 0xffff0000, v20
    v_add_f32 v24, v24, v20
    v_add_f32 v24, v24, v21
    v_lshlrev_b32 v20, 16, v130
    v_and_b32 v21, 0xffff0000, v130
    v_lshlrev_b32 v22, 16, v134
    v_and_b32 v23, 0xffff0000, v134
    v_mul_f32 v20, v20, v22
    v_mul_f32 v21, v21, v23
    v_cvt_pk_bf16_f32 v20, v20, v21
    v_lshlrev_b32 v21, 16, v20
    v_and_b32 v20, 0xffff0000, v20
    v_add_f32 v24, v24, v20
    v_add_f32 v24, v24, v21
    v_lshlrev_b32 v20, 16, v131
    v_and_b32 v21, 0xffff0000, v131
    v_lshlrev_b32 v22, 16, v135
    v_and_b32 v23, 0xffff0000, v135
    v_mul_f32 v20, v20, v22
    v_mul_f32 v21, v21, v23
    v_cvt_pk_bf16_f32 v20, v20, v21
    v_lshlrev_b32 v21, 16, v20
    v_and_b32 v20, 0xffff0000, v20
    v_add_f32 v24, v24, v20
    v_add_f32 v24, v24, v21
    s_nop 1
    v_add_f32_dpp v24, v24, v24 row_ror:1 row_mask:0xf bank_mask:0xf
    s_nop 1
    v_add_f32_dpp v24, v24, v24 row_ror:2 row_mask:0xf bank_mask:0xf
    s_nop 1
    v_add_f32_dpp v24, v24, v24 row_ror:4 row_mask:0xf bank_mask:0xf
    s_nop 1
    v_add_f32_dpp v24, v24, v24 row_ror:8 row_mask:0xf bank_mask:0xf
    v_mov_b32 v25, v24
    s_nop 1
    v_permlane16_swap_b32 v24, v25
    v_add_f32 v24, v24, v25
    v_mov_b32 v25, v24
    s_nop 1
    v_permlane32_swap_b32 v24, v25
    v_add_f32 v24, v24, v25
    v_cvt_pk_bf16_f32 v24, v24, v24
    v_and_b32 v24, 0xffff0000, v24
    v_mul_f32 v24, 0xbfb8aa3b, v24
    v_exp_f32 v24, v24
    s_nop 0
    v_add_f32 v24, 1.0, v24
    v_rcp_f32 v24, v24
    s_nop 0
    v_cvt_pk_bf16_f32 v24, v24, v24
    v_and_b32 v136, 0xffff0000, v24
    v_sub_f32 v24, 1.0, v136
    v_cvt_pk_bf16_f32 v24, v24, v24
    v_and_b32 v137, 0xffff0000, v24
    s_mov_b32 exec_lo, 0
    v_mov_b32 v136, v137
    s_mov_b32 exec_lo, -1
L_GOW:
    s_mov_b32 s70, 1600000
LW_48:
    ds_read_b32 v59, v61 offset:4116
    s_waitcnt lgkmcnt(0)
    v_readfirstlane_b32 s71, v59
    s_cmp_ge_u32 s71, 16
    s_cbranch_scc1 LWD_49
    s_sleep 2
    s_sub_u32 s70, s70, 1
    s_cmp_lg_u32 s70, 0
    s_cbranch_scc1 LW_48
LWD_49:
    s_mov_b32 s66, 0x0c0c0400
    s_pack_hh_b32_b16 s65, s94, s94
    s_lshr_b32 s62, s94, 16
    s_mov_b32 s61, s66
    s_mov_b32 s70, 100000
    s_branch L_RPOLLX0
L_RPOLL0:
    s_sleep 4
L_RPOLLX0:
    buffer_load_dwordx4 v[12:15], v81, s[24:27], s88 offen offset:0 sc1
    buffer_load_dwordx4 v[16:19], v81, s[24:27], s88 offen offset:64 sc1
L_RCHK0:
    s_waitcnt vmcnt(0)
L_RCHKX0:
    v_perm_b32 v56, v15, v14, s66
    v_perm_b32 v57, v19, v18, s66
    v_lshl_or_b32 v56, v57, 16, v56
    v_cmp_ne_u32 vcc, s65, v56
    s_cbranch_vccz L_RDONE0
    s_or_b32 s71, vcc_lo, vcc_hi
    s_lshr_b32 s72, s71, 16
    s_or_b32 s71, s71, s72
    s_pack_ll_b32_b16 s71, s71, s71
    s_mov_b32 exec_lo, s71
    s_mov_b32 exec_hi, s71
    s_sub_u32 s70, s70, 1
    s_cmp_lg_u32 s70, 0
    s_cbranch_scc1 L_RPOLL0
    s_mov_b32 s70, 1
L_RDONE0:
    s_mov_b64 exec, -1
    buffer_load_dwordx4 v[20:23], v81, s[24:27], s89 offen offset:0 sc1
    buffer_load_dwordx4 v[24:27], v81, s[24:27], s89 offen offset:64 sc1
    v_perm_b32 v56, v13, v12, s66
    v_perm_b32 v57, v17, v16, s66
    v_lshl_or_b32 v56, v57, 16, v56
    v_mov_b32 v58, v56
    v_and_b32 v14, 0xffffff00, v14
    v_and_b32 v15, 0xffffff00, v15
    v_and_b32 v18, 0xffffff00, v18
    v_and_b32 v19, 0xffffff00, v19
    v_max_f32_dpp v58, v58, v58 quad_perm:[1,0,3,2] row_mask:0xf bank_mask:0xf
    s_nop 1
    v_max_f32_dpp v58, v58, v58 quad_perm:[2,3,0,1] row_mask:0xf bank_mask:0xf
    s_nop 1
    v_max_f32_dpp v58, v58, v58 row_half_mirror row_mask:0xf bank_mask:0xf
    v_sub_f32 v58, v56, v58
    v_exp_f32 v58, v58
    s_nop 0
    v_mov_b32 v57, v58
    v_mul_f32 v12, v12, v58
    v_mul_f32 v13, v13, v58
    v_mul_f32 v14, v14, v58
    v_mul_f32 v15, v15, v58
    v_mul_f32 v16, v16, v58
    v_mul_f32 v17, v17, v58
    v_mul_f32 v18, v18, v58
    v_mul_f32 v19, v19, v58
    v_add_f32_dpp v57, v57, v57 quad_perm:[1,0,3,2] row_mask:0xf bank_mask:0xf
    v_add_f32_dpp v12, v12, v12 quad_perm:[1,0,3,2] row_mask:0xf bank_mask:0xf
    v_add_f32_dpp v13, v13, v13 quad_perm:[1,0,3,2] row_mask:0xf bank_mask:0xf
    v_add_f32_dpp v14, v14, v14 quad_perm:[1,0,3,2] row_mask:0xf bank_mask:0xf
    v_add_f32_dpp v15, v15, v15 quad_perm:[1,0,3,2] row_mask:0xf bank_mask:0xf
    v_add_f32_dpp v16, v16, v16 quad_perm:[1,0,3,2] row_mask:0xf bank_mask:0xf
    v_add_f32_dpp v17, v17, v17 quad_perm:[1,0,3,2] row_mask:0xf bank_mask:0xf
    v_add_f32_dpp v18, v18, v18 quad_perm:[1,0,3,2] row_mask:0xf bank_mask:0xf
    v_add_f32_dpp v19, v19, v19 quad_perm:[1,0,3,2] row_mask:0xf bank_mask:0xf
    v_add_f32_dpp v57, v57, v57 quad_perm:[2,3,0,1] row_mask:0xf bank_mask:0xf
    v_add_f32_dpp v12, v12, v12 quad_perm:[2,3,0,1] row_mask:0xf bank_mask:0xf
    v_add_f32_dpp v13, v13, v13 quad_perm:[2,3,0,1] row_mask:0xf bank_mask:0xf
    v_add_f32_dpp v14, v14, v14 quad_perm:[2,3,0,1] row_mask:0xf bank_mask:0xf
    v_add_f32_dpp v15, v15, v15 quad_perm:[2,3,0,1] row_mask:0xf bank_mask:0xf
    v_add_f32_dpp v16, v16, v16 quad_perm:[2,3,0,1] row_mask:0xf bank_mask:0xf
    v_add_f32_dpp v17, v17, v17 quad_perm:[2,3,0,1] row_mask:0xf bank_mask:0xf
    v_add_f32_dpp v18, v18, v18 quad_perm:[2,3,0,1] row_mask:0xf bank_mask:0xf
    v_add_f32_dpp v19, v19, v19 quad_perm:[2,3,0,1] row_mask:0xf bank_mask:0xf
    v_add_f32_dpp v57, v57, v57 row_half_mirror row_mask:0xf bank_mask:0xf
    v_add_f32_dpp v12, v12, v12 row_half_mirror row_mask:0xf bank_mask:0xf
    v_add_f32_dpp v13, v13, v13 row_half_mirror row_mask:0xf bank_mask:0xf
    v_add_f32_dpp v14, v14, v14 row_half_mirror row_mask:0xf bank_mask:0xf
    v_add_f32_dpp v15, v15, v15 row_half_mirror row_mask:0xf bank_mask:0xf
    v_add_f32_dpp v16, v16, v16 row_half_mirror row_mask:0xf bank_mask:0xf
    v_add_f32_dpp v17, v17, v17 row_half_mirror row_mask:0xf bank_mask:0xf
    v_add_f32_dpp v18, v18, v18 row_half_mirror row_mask:0xf bank_mask:0xf
    v_add_f32_dpp v19, v19, v19 row_half_mirror row_mask:0xf bank_mask:0xf
    v_rcp_f32 v57, v57
    s_nop 0
    v_mul_f32 v12, v12, v57
    v_mul_f32 v13, v13, v57
    v_mul_f32 v14, v14, v57
    v_mul_f32 v15, v15, v57
    v_mul_f32 v16, v16, v57
    v_mul_f32 v17, v17, v57
    v_mul_f32 v18, v18, v57
    v_mul_f32 v19, v19, v57
    v_cvt_pk_bf16_f32 v12, v12, v13
    v_cvt_pk_bf16_f32 v13, v14, v15
    v_cvt_pk_bf16_f32 v14, v16, v17
    v_cvt_pk_bf16_f32 v15, v18, v19
    v_perm_b32 v44, v12, v12, v4
    v_perm_b32 v45, v12, v12, v5
    v_perm_b32 v46, v12, v12, v6
    v_perm_b32 v47, v12, v12, v7
    s_nop 1
    v_mfma_f32_16x16x32_bf16 v[28:31], v[44:47], v[192:195], 0
    v_perm_b32 v48, v12, v12, v8
    v_perm_b32 v49, v12, v12, v9
    v_perm_b32 v50, v12, v12, v10
    v_perm_b32 v51, v12, v12, v11
    s_nop 1
    v_mfma_f32_16x16x32_bf16 v[32:35], v[48:51], v[196:199], 0
    v_perm_b32 v44, v13, v13, v4
    v_perm_b32 v45, v13, v13, v5
    v_perm_b32 v46, v13, v13, v6
    v_perm_b32 v47, v13, v13, v7
    s_nop 1
    v_mfma_f32_16x16x32_bf16 v[28:31], v[44:47], v[200:203], v[28:31]
    v_perm_b32 v48, v13, v13, v8
    v_perm_b32 v49, v13, v13, v9
    v_perm_b32 v50, v13, v13, v10
    v_perm_b32 v51, v13, v13, v11
    s_nop 1
    v_mfma_f32_16x16x32_bf16 v[32:35], v[48:51], v[204:207], v[32:35]
    v_perm_b32 v44, v14, v14, v4
    v_perm_b32 v45, v14, v14, v5
    v_perm_b32 v46, v14, v14, v6
    v_perm_b32 v47, v14, v14, v7
    s_nop 1
    v_mfma_f32_16x16x32_bf16 v[28:31], v[44:47], v[208:211], v[28:31]
    v_perm_b32 v48, v14, v14, v8
    v_perm_b32 v49, v14, v14, v9
    v_perm_b32 v50, v14, v14, v10
    v_perm_b32 v51, v14, v14, v11
    s_nop 1
    v_mfma_f32_16x16x32_bf16 v[32:35], v[48:51], v[212:215], v[32:35]
    v_perm_b32 v44, v15, v15, v4
    v_perm_b32 v45, v15, v15, v5
    v_perm_b32 v46, v15, v15, v6
    v_perm_b32 v47, v15, v15, v7
    s_nop 1
    v_mfma_f32_16x16x32_bf16 v[28:31], v[44:47], v[216:219], v[28:31]
    v_perm_b32 v48, v15, v15, v8
    v_perm_b32 v49, v15, v15, v9
    v_perm_b32 v50, v15, v15, v10
    v_perm_b32 v51, v15, v15, v11
    s_nop 1
    v_mfma_f32_16x16x32_bf16 v[32:35], v[48:51], v[220:223], v[32:35]
    s_nop 7
    v_add_f32 v28, v28, v32
    v_add_f32 v29, v29, v33
    v_add_f32 v30, v30, v34
    v_add_f32 v31, v31, v35
    ds_write_b128 v82, v[28:31] offset:5120
    s_mov_b64 exec, 1
    ds_add_rtn_u32 v59, v61, v60 offset:4148
    s_mov_b64 exec, -1
    s_waitcnt lgkmcnt(0)
    v_readfirstlane_b32 s71, v59
    s_cmp_lg_u32 s71, 3
    s_cbranch_scc1 L_NY0
    ds_read_b128 v[44:47], v40 offset:5120
    ds_read_b128 v[48:51], v40 offset:7168
    ds_read_b128 v[52:55], v40 offset:9216
    ds_read_b128 v[56:59], v40 offset:11264
    s_waitcnt lgkmcnt(2)
    v_add_f32 v44, v44, v48
    v_add_f32 v45, v45, v49
    v_add_f32 v46, v46, v50
    v_add_f32 v47, v47, v51
    s_waitcnt lgkmcnt(0)
    v_add_f32 v52, v52, v56
    v_add_f32 v53, v53, v57
    v_add_f32 v54, v54, v58
    v_add_f32 v55, v55, v59
    v_add_f32 v140, v44, v52
    v_add_f32 v141, v45, v53
    v_add_f32 v142, v46, v54
    v_add_f32 v143, v47, v55
    v_perm_b32 v142, v142, v38, s78
    v_perm_b32 v143, v143, v38, s79
    s_waitcnt vmcnt(0)
    buffer_store_dwordx4 v[140:143], v83, s[24:27], s92 offen sc1
    s_branch L_RCHKX1
L_NY0:
    s_branch L_RCHK1
L_RPOLL1:
    s_sleep 4
L_RPOLLX1:
    buffer_load_dwordx4 v[20:23], v81, s[24:27], s89 offen offset:0 sc1
    buffer_load_dwordx4 v[24:27], v81, s[24:27], s89 offen offset:64 sc1
L_RCHK1:
    s_waitcnt vmcnt(0)
L_RCHKX1:
    v_perm_b32 v56, v23, v22, s66
    v_perm_b32 v57, v27, v26, s66
    v_lshl_or_b32 v56, v57, 16, v56
    v_cmp_ne_u32 vcc, s65, v56
    s_cbranch_vccz L_RDONE1
    s_or_b32 s71, vcc_lo, vcc_hi
    s_lshr_b32 s72, s71, 16
    s_or_b32 s71, s71, s72
    s_pack_ll_b32_b16 s71, s71, s71
    s_mov_b32 exec_lo, s71
    s_mov_b32 exec_hi, s71
    s_sub_u32 s70, s70, 1
    s_cmp_lg_u32 s70, 0
    s_cbranch_scc1 L_RPOLL1
    s_mov_b32 s70, 1
L_RDONE1:
    s_mov_b64 exec, -1
    v_perm_b32 v56, v21, v20, s66
    v_perm_b32 v57, v25, v24, s66
    v_lshl_or_b32 v56, v57, 16, v56
    v_mov_b32 v58, v56
    v_and_b32 v22, 0xffffff00, v22
    v_and_b32 v23, 0xffffff00, v23
    v_and_b32 v26, 0xffffff00, v26
    v_and_b32 v27, 0xffffff00, v27
    v_max_f32_dpp v58, v58, v58 quad_perm:[1,0,3,2] row_mask:0xf bank_mask:0xf
    s_nop 1
    v_max_f32_dpp v58, v58, v58 quad_perm:[2,3,0,1] row_mask:0xf bank_mask:0xf
    s_nop 1
    v_max_f32_dpp v58, v58, v58 row_half_mirror row_mask:0xf bank_mask:0xf
    v_sub_f32 v58, v56, v58
    v_exp_f32 v58, v58
    s_nop 0
    v_mov_b32 v57, v58
    v_mul_f32 v20, v20, v58
    v_mul_f32 v21, v21, v58
    v_mul_f32 v22, v22, v58
    v_mul_f32 v23, v23, v58
    v_mul_f32 v24, v24, v58
    v_mul_f32 v25, v25, v58
    v_mul_f32 v26, v26, v58
    v_mul_f32 v27, v27, v58
    v_add_f32_dpp v57, v57, v57 quad_perm:[1,0,3,2] row_mask:0xf bank_mask:0xf
    v_add_f32_dpp v20, v20, v20 quad_perm:[1,0,3,2] row_mask:0xf bank_mask:0xf
    v_add_f32_dpp v21, v21, v21 quad_perm:[1,0,3,2] row_mask:0xf bank_mask:0xf
    v_add_f32_dpp v22, v22, v22 quad_perm:[1,0,3,2] row_mask:0xf bank_mask:0xf
    v_add_f32_dpp v23, v23, v23 quad_perm:[1,0,3,2] row_mask:0xf bank_mask:0xf
    v_add_f32_dpp v24, v24, v24 quad_perm:[1,0,3,2] row_mask:0xf bank_mask:0xf
    v_add_f32_dpp v25, v25, v25 quad_perm:[1,0,3,2] row_mask:0xf bank_mask:0xf
    v_add_f32_dpp v26, v26, v26 quad_perm:[1,0,3,2] row_mask:0xf bank_mask:0xf
    v_add_f32_dpp v27, v27, v27 quad_perm:[1,0,3,2] row_mask:0xf bank_mask:0xf
    v_add_f32_dpp v57, v57, v57 quad_perm:[2,3,0,1] row_mask:0xf bank_mask:0xf
    v_add_f32_dpp v20, v20, v20 quad_perm:[2,3,0,1] row_mask:0xf bank_mask:0xf
    v_add_f32_dpp v21, v21, v21 quad_perm:[2,3,0,1] row_mask:0xf bank_mask:0xf
    v_add_f32_dpp v22, v22, v22 quad_perm:[2,3,0,1] row_mask:0xf bank_mask:0xf
    v_add_f32_dpp v23, v23, v23 quad_perm:[2,3,0,1] row_mask:0xf bank_mask:0xf
    v_add_f32_dpp v24, v24, v24 quad_perm:[2,3,0,1] row_mask:0xf bank_mask:0xf
    v_add_f32_dpp v25, v25, v25 quad_perm:[2,3,0,1] row_mask:0xf bank_mask:0xf
    v_add_f32_dpp v26, v26, v26 quad_perm:[2,3,0,1] row_mask:0xf bank_mask:0xf
    v_add_f32_dpp v27, v27, v27 quad_perm:[2,3,0,1] row_mask:0xf bank_mask:0xf
    v_add_f32_dpp v57, v57, v57 row_half_mirror row_mask:0xf bank_mask:0xf
    v_add_f32_dpp v20, v20, v20 row_half_mirror row_mask:0xf bank_mask:0xf
    v_add_f32_dpp v21, v21, v21 row_half_mirror row_mask:0xf bank_mask:0xf
    v_add_f32_dpp v22, v22, v22 row_half_mirror row_mask:0xf bank_mask:0xf
    v_add_f32_dpp v23, v23, v23 row_half_mirror row_mask:0xf bank_mask:0xf
    v_add_f32_dpp v24, v24, v24 row_half_mirror row_mask:0xf bank_mask:0xf
    v_add_f32_dpp v25, v25, v25 row_half_mirror row_mask:0xf bank_mask:0xf
    v_add_f32_dpp v26, v26, v26 row_half_mirror row_mask:0xf bank_mask:0xf
    v_add_f32_dpp v27, v27, v27 row_half_mirror row_mask:0xf bank_mask:0xf
    v_rcp_f32 v57, v57
    s_nop 0
    v_mul_f32 v20, v20, v57
    v_mul_f32 v21, v21, v57
    v_mul_f32 v22, v22, v57
    v_mul_f32 v23, v23, v57
    v_mul_f32 v24, v24, v57
    v_mul_f32 v25, v25, v57
    v_mul_f32 v26, v26, v57
    v_mul_f32 v27, v27, v57
    v_cvt_pk_bf16_f32 v20, v20, v21
    v_cvt_pk_bf16_f32 v21, v22, v23
    v_cvt_pk_bf16_f32 v22, v24, v25
    v_cvt_pk_bf16_f32 v23, v26, v27
    v_perm_b32 v44, v20, v20, v4
    v_perm_b32 v45, v20, v20, v5
    v_perm_b32 v46, v20, v20, v6
    v_perm_b32 v47, v20, v20, v7
    s_nop 1
    v_mfma_f32_16x16x32_bf16 v[28:31], v[44:47], v[192:195], 0
    v_perm_b32 v48, v20, v20, v8
    v_perm_b32 v49, v20, v20, v9
    v_perm_b32 v50, v20, v20, v10
    v_perm_b32 v51, v20, v20, v11
    s_nop 1
    v_mfma_f32_16x16x32_bf16 v[32:35], v[48:51], v[196:199], 0
    v_perm_b32 v44, v21, v21, v4
    v_perm_b32 v45, v21, v21, v5
    v_perm_b32 v46, v21, v21, v6
    v_perm_b32 v47, v21, v21, v7
    s_nop 1
    v_mfma_f32_16x16x32_bf16 v[28:31], v[44:47], v[200:203], v[28:31]
    v_perm_b32 v48, v21, v21, v8
    v_perm_b32 v49, v21, v21, v9
    v_perm_b32 v50, v21, v21, v10
    v_perm_b32 v51, v21, v21, v11
    s_nop 1
    v_mfma_f32_16x16x32_bf16 v[32:35], v[48:51], v[204:207], v[32:35]
    v_perm_b32 v44, v22, v22, v4
    v_perm_b32 v45, v22, v22, v5
    v_perm_b32 v46, v22, v22, v6
    v_perm_b32 v47, v22, v22, v7
    s_nop 1
    v_mfma_f32_16x16x32_bf16 v[28:31], v[44:47], v[208:211], v[28:31]
    v_perm_b32 v48, v22, v22, v8
    v_perm_b32 v49, v22, v22, v9
    v_perm_b32 v50, v22, v22, v10
    v_perm_b32 v51, v22, v22, v11
    s_nop 1
    v_mfma_f32_16x16x32_bf16 v[32:35], v[48:51], v[212:215], v[32:35]
    v_perm_b32 v44, v23, v23, v4
    v_perm_b32 v45, v23, v23, v5
    v_perm_b32 v46, v23, v23, v6
    v_perm_b32 v47, v23, v23, v7
    s_nop 1
    v_mfma_f32_16x16x32_bf16 v[28:31], v[44:47], v[216:219], v[28:31]
    v_perm_b32 v48, v23, v23, v8
    v_perm_b32 v49, v23, v23, v9
    v_perm_b32 v50, v23, v23, v10
    v_perm_b32 v51, v23, v23, v11
    s_nop 1
    v_mfma_f32_16x16x32_bf16 v[32:35], v[48:51], v[220:223], v[32:35]
    s_nop 7
    v_add_f32 v28, v28, v32
    v_add_f32 v29, v29, v33
    v_add_f32 v30, v30, v34
    v_add_f32 v31, v31, v35
    ds_write_b128 v82, v[28:31] offset:6144
    s_mov_b64 exec, 1
    ds_add_rtn_u32 v59, v61, v60 offset:4152
    s_mov_b64 exec, -1
    s_waitcnt lgkmcnt(0)
    v_readfirstlane_b32 s71, v59
    s_cmp_lg_u32 s71, 3
    s_cbranch_scc1 L_NY1
    ds_read_b128 v[44:47], v40 offset:6144
    ds_read_b128 v[48:51], v40 offset:8192
    ds_read_b128 v[52:55], v40 offset:10240
    ds_read_b128 v[56:59], v40 offset:12288
    s_waitcnt lgkmcnt(2)
    v_add_f32 v44, v44, v48
    v_add_f32 v45, v45, v49
    v_add_f32 v46, v46, v50
    v_add_f32 v47, v47, v51
    s_waitcnt lgkmcnt(0)
    v_add_f32 v52, v52, v56
    v_add_f32 v53, v53, v57
    v_add_f32 v54, v54, v58
    v_add_f32 v55, v55, v59
    v_add_f32 v144, v44, v52
    v_add_f32 v145, v45, v53
    v_add_f32 v146, v46, v54
    v_add_f32 v147, v47, v55
    v_perm_b32 v146, v146, v38, s78
    v_perm_b32 v147, v147, v38, s79
    buffer_store_dwordx4 v[144:147], v83, s[24:27], s93 offen sc1
L_NY1:
    s_cmp_eq_u32 s91, 0
    s_cbranch_scc1 F_FLUSH
    s_lshl_b32 s66, s90, 13
    s_add_u32 s66, s66, 1048576
    s_add_u32 s67, s66, 0x1000
    s_mov_b32 s70, 100000
    v_lshlrev_b32 v41, 3, v0
    s_lshl_b32 s63, s90, 6
F_POLL:
    buffer_load_dwordx4 v[96:99], v40, s[24:27], s66 offen offset:0 sc1
    buffer_load_dwordx4 v[100:103], v40, s[24:27], s66 offen offset:1024 sc1
    buffer_load_dwordx4 v[104:107], v40, s[24:27], s66 offen offset:2048 sc1
    buffer_load_dwordx4 v[108:111], v40, s[24:27], s66 offen offset:3072 sc1
    buffer_load_dwordx4 v[112:115], v40, s[24:27], s67 offen offset:0 sc1
    buffer_load_dwordx4 v[116:119], v40, s[24:27], s67 offen offset:1024 sc1
    buffer_load_dwordx4 v[120:123], v40, s[24:27], s67 offen offset:2048 sc1
    buffer_load_dwordx4 v[124:127], v40, s[24:27], s67 offen offset:3072 sc1
    s_waitcnt vmcnt(7)
    v_perm_b32 v13, v99, v98, s61
    v_sad_u32 v12, v13, s62, 0
    v_and_b32 v98, 0xffffff00, v98
    v_and_b32 v99, 0xffffff00, v99
    s_waitcnt vmcnt(6)
    v_perm_b32 v13, v103, v102, s61
    v_sad_u32 v12, v13, s62, v12
    v_and_b32 v102, 0xffffff00, v102
    v_and_b32 v103, 0xffffff00, v103
    s_waitcnt vmcnt(5)
    v_perm_b32 v13, v107, v106, s61
    v_sad_u32 v12, v13, s62, v12
    v_and_b32 v106, 0xffffff00, v106
    v_and_b32 v107, 0xffffff00, v107
    s_waitcnt vmcnt(4)
    v_perm_b32 v13, v111, v110, s61
    v_sad_u32 v12, v13, s62, v12
    v_and_b32 v110, 0xffffff00, v110
    v_and_b32 v111, 0xffffff00, v111
    s_waitcnt vmcnt(3)
    v_perm_b32 v13, v115, v114, s61
    v_sad_u32 v12, v13, s62, v12
    v_and_b32 v114, 0xffffff00, v114
    v_and_b32 v115, 0xffffff00, v115
    s_waitcnt vmcnt(2)
    v_perm_b32 v13, v119, v118, s61
    v_sad_u32 v12, v13, s62, v12
    v_and_b32 v118, 0xffffff00, v118
    v_and_b32 v119, 0xffffff00, v119
    s_waitcnt vmcnt(1)
    v_perm_b32 v13, v123, v122, s61
    v_sad_u32 v12, v13, s62, v12
    v_and_b32 v122, 0xffffff00, v122
    v_and_b32 v123, 0xffffff00, v123
    s_waitcnt vmcnt(0)
    v_perm_b32 v13, v127, v126, s61
    v_sad_u32 v12, v13, s62, v12
    v_and_b32 v126, 0xffffff00, v126
    v_and_b32 v127, 0xffffff00, v127
    v_cmp_ne_u32 vcc, 0, v12
    s_cbranch_vccz F_DONE
    s_wqm_b64 exec, vcc
    s_sub_u32 s70, s70, 1
    s_cmp_lg_u32 s70, 0
    s_cbranch_scc1 F_POLL
F_DONE:
    s_mov_b64 exec, -1
    v_add_f32 v96, v96, v100
    v_add_f32 v104, v104, v108
    v_add_f32 v97, v97, v101
    v_add_f32 v105, v105, v109
    v_add_f32 v98, v98, v102
    v_add_f32 v106, v106, v110
    v_add_f32 v99, v99, v103
    v_add_f32 v107, v107, v111
    v_add_f32 v96, v96, v104
    v_add_f32 v97, v97, v105
    v_add_f32 v98, v98, v106
    v_add_f32 v99, v99, v107
    v_add_f32 v112, v112, v116
    v_add_f32 v120, v120, v124
    v_add_f32 v113, v113, v117
    v_add_f32 v121, v121, v125
    v_add_f32 v114, v114, v118
    v_add_f32 v122, v122, v126
    v_add_f32 v115, v115, v119
    v_add_f32 v123, v123, v127
    v_add_f32 v112, v112, v120
    v_add_f32 v113, v113, v121
    v_add_f32 v114, v114, v122
    v_add_f32 v115, v115, v123
    v_permlane32_swap_b32 v96, v112
    v_permlane32_swap_b32 v97, v113
    v_permlane32_swap_b32 v98, v114
    v_permlane32_swap_b32 v99, v115
    v_add_f32 v96, v96, v112
    v_add_f32 v97, v97, v113
    v_add_f32 v98, v98, v114
    v_add_f32 v99, v99, v115
    v_mov_b32 v100, v96
    v_mov_b32 v101, v97
    v_mov_b32 v102, v98
    v_mov_b32 v103, v99
    v_permlane16_swap_b32 v96, v100
    v_permlane16_swap_b32 v97, v101
    v_permlane16_swap_b32 v98, v102
    v_permlane16_swap_b32 v99, v103
    v_add_f32 v96, v96, v100
    v_add_f32 v97, v97, v101
    v_add_f32 v98, v98, v102
    v_add_f32 v99, v99, v103
    v_add_f32_dpp v96, v96, v96 row_ror:8 row_mask:0xf bank_mask:0xf
    v_add_f32_dpp v97, v97, v97 row_ror:8 row_mask:0xf bank_mask:0xf
    v_add_f32_dpp v98, v98, v98 row_ror:8 row_mask:0xf bank_mask:0xf
    v_add_f32_dpp v99, v99, v99 row_ror:8 row_mask:0xf bank_mask:0xf
    v_cvt_pk_bf16_f32 v100, v96, v97
    v_cvt_pk_bf16_f32 v101, v98, v99
    v_lshlrev_b32 v96, 16, v100
    v_and_b32 v97, 0xffff0000, v100
    v_lshlrev_b32 v98, 16, v101
    v_and_b32 v99, 0xffff0000, v101
    v_mul_f32 v96, v96, v136
    v_mul_f32 v97, v97, v136
    v_mul_f32 v98, v98, v136
    v_mul_f32 v99, v99, v136
    v_cvt_pk_bf16_f32 v100, v96, v97
    v_cvt_pk_bf16_f32 v101, v98, v99
    v_lshlrev_b32 v96, 16, v100
    v_and_b32 v97, 0xffff0000, v100
    v_lshlrev_b32 v98, 16, v101
    v_and_b32 v99, 0xffff0000, v101
    v_mov_b32 v104, v96
    v_mov_b32 v105, v97
    v_mov_b32 v106, v98
    v_mov_b32 v107, v99
    v_permlane32_swap_b32 v96, v104
    v_permlane32_swap_b32 v97, v105
    v_permlane32_swap_b32 v98, v106
    v_permlane32_swap_b32 v99, v107
    v_add_f32 v96, v96, v104
    v_add_f32 v97, v97, v105
    v_add_f32 v98, v98, v106
    v_add_f32 v99, v99, v107
    v_cvt_pk_bf16_f32 v100, v96, v97
    v_cvt_pk_bf16_f32 v101, v98, v99
    s_mov_b64 exec, 0xff
    buffer_store_dwordx2 v[100:101], v41, s[36:39], s63 offen
    s_cmp_lg_u32 s90, 48
    s_cbranch_scc1 L_NOEP
    v_mov_b32 v44, s95
    s_mov_b32 s60, 3932160
    s_mov_b64 exec, 1
    buffer_store_dword v44, off, s[24:27], s60
L_NOEP:
F_FLUSH:
L_END:
    s_endpgm
L_FMERGE:
    ds_read_b128 v[32:35], v235 offset:23936
    ds_read_b128 v[12:15], v235 offset:23952
    ds_read_b128 v[16:19], v235 offset:23968
    ds_read_b128 v[20:23], v235 offset:23984
    ds_read_b128 v[24:27], v235 offset:24000
    ds_read_b128 v[44:47], v36 offset:21888
    ds_read_b128 v[48:51], v36 offset:22400
    ds_read_b128 v[52:55], v36 offset:22912
    ds_read_b128 v[56:59], v36 offset:23424
    s_waitcnt lgkmcnt(8)
    v_max3_f32 v28, v32, v33, v34
    v_max_f32 v28, v28, v35
    v_sub_f32 v32, v32, v28
    v_sub_f32 v33, v33, v28
    v_sub_f32 v34, v34, v28
    v_sub_f32 v35, v35, v28
    v_mul_f32 v32, s75, v32
    v_mul_f32 v33, s75, v33
    v_mul_f32 v34, s75, v34
    v_mul_f32 v35, s75, v35
    v_exp_f32 v32, v32
    v_exp_f32 v33, v33
    v_exp_f32 v34, v34
    v_exp_f32 v35, v35
    s_waitcnt lgkmcnt(4)
    v_add_f32 v12, v12, v13
    v_add_f32 v14, v14, v15
    v_add_f32 v12, v12, v14
    v_add_f32 v16, v16, v17
    v_add_f32 v18, v18, v19
    v_add_f32 v16, v16, v18
    v_add_f32 v20, v20, v21
    v_add_f32 v22, v22, v23
    v_add_f32 v20, v20, v22
    v_add_f32 v24, v24, v25
    v_add_f32 v26, v26, v27
    v_add_f32 v24, v24, v26
    v_mul_f32 v29, v12, v32
    v_fmac_f32 v29, v16, v33
    v_fmac_f32 v29, v20, v34
    v_fmac_f32 v29, v24, v35
    v_rcp_f32 v30, v29
    v_log_f32 v31, v29
    s_waitcnt lgkmcnt(0)
    v_mul_f32 v12, v44, v32
    v_mul_f32 v13, v45, v32
    v_mul_f32 v14, v46, v32
    v_mul_f32 v15, v47, v32
    v_fmac_f32 v12, v48, v33
    v_fmac_f32 v13, v49, v33
    v_fmac_f32 v14, v50, v33
    v_fmac_f32 v15, v51, v33
    v_fmac_f32 v12, v52, v34
    v_fmac_f32 v13, v53, v34
    v_fmac_f32 v14, v54, v34
    v_fmac_f32 v15, v55, v34
    v_fmac_f32 v12, v56, v35
    v_fmac_f32 v13, v57, v35
    v_fmac_f32 v14, v58, v35
    v_fmac_f32 v15, v59, v35
    v_fmac_f32 v31, s75, v28
    v_mul_f32 v12, v12, v30
    v_mul_f32 v13, v13, v30
    v_mul_f32 v14, v14, v30
    v_mul_f32 v15, v15, v30
    v_perm_b32 v31, s94, v31, v37
    v_perm_b32 v12, v12, v31, s76
    v_perm_b32 v13, v13, v31, s77
    v_perm_b32 v14, v14, v31, s78
    v_perm_b32 v15, v15, v31, s79
    s_mov_b32 exec_hi, 0
    buffer_store_dwordx4 v[12:15], v40, s[24:27], s64 offen sc1
    s_mov_b32 exec_hi, -1
    s_branch L_SEND
.section .rodata,"a"
.p2align 6
.amdhsa_kernel gated_mix__mha_block_cached__sliding_block_cached__decode_kernel
  .amdhsa_next_free_vgpr 256
  .amdhsa_next_free_sgpr 102
  .amdhsa_accum_offset 256
  .amdhsa_group_segment_fixed_size 0
  .amdhsa_kernarg_size 112
  .amdhsa_user_sgpr_count 2
  .amdhsa_user_sgpr_kernarg_segment_ptr 1
  .amdhsa_system_sgpr_workgroup_id_x 1
.end_amdhsa_kernel
```
